```python
import torch

def _softmax(x, axis=-1):
    return torch.softmax(x, dim=axis)
def _gelu(x):
    return torch.nn.functional.gelu(x, approximate="tanh")
def _silu(x):
    return torch.nn.functional.silu(x)
def _sigmoid(x):
    return torch.sigmoid(x)
def _layernorm(x, axis=-1, eps=1e-5):
    m = x.mean(dim=axis, keepdim=True)
    v = x.var(dim=axis, keepdim=True, unbiased=False)
    return (x - m) / torch.sqrt(v + eps)
def _scatter_add(tgt, idx, src, axis=0):
    return tgt.clone().index_add_(axis, idx, src)
def _segment_sum(src, seg, n):
    out = torch.zeros((n,) + src.shape[1:], dtype=src.dtype)
    return out.index_add_(0, seg, src)
def _pad(x, pw):
    flat = tuple(v for pair in reversed(pw) for v in pair)
    return torch.nn.functional.pad(x, flat)

kernel_name = 'standalone__gqa_softmax__near_ridge'

def setup_inputs():

    _w = (lambda a: (lambda t: t.to(torch.bfloat16) if t.is_floating_point() else t)(torch.as_tensor(a)))
    B, Hq, Hkv, Sq, Sk, D = 16, 32, 8, 256, 256, 128
    return {
        "q": _w((lambda *s: torch.randn(*s, dtype=torch.bfloat16) * 0.8)(B, Hq, Sq, D)),
        "k": _w((lambda *s: torch.randn(*s, dtype=torch.bfloat16) * 0.8)(B, Hkv, Sk, D)),
        "v": _w((lambda *s: torch.randn(*s, dtype=torch.bfloat16) * 0.05)(B, Hkv, Sk, D)),
    }

def reference(q, k, v):
    B, Hq, Sq, D = q.shape
    Hkv = k.shape[1]
    rep = Hq // Hkv
    k = (lambda x, n, axis: torch.repeat_interleave(x, n, dim=axis))(k, rep, axis=1)
    v = (lambda x, n, axis: torch.repeat_interleave(x, n, dim=axis))(v, rep, axis=1)
    scale = D ** -0.5
    scores = torch.einsum("bhqd,bhkd->bhqk", q, k) * scale
    p = _softmax(scores, axis=-1)
    return torch.einsum("bhqk,bhkd->bhqd", p, v)
```

```asm
; @launch grid=(256,1,1) block=(512,1,1) lds=163840
.amdgcn_target "amdgcn-amd-amdhsa--gfx950"
.text
.globl standalone__gqa_softmax__near_ridge_kernel
.p2align 8
.type standalone__gqa_softmax__near_ridge_kernel,@function
standalone__gqa_softmax__near_ridge_kernel:
    s_cmp_ge_u32 s2, 256
    s_cbranch_scc1 L_end
    s_load_dwordx4 s[4:7], s[0:1], 0
    s_load_dwordx4 s[32:35], s[0:1], 16
    v_lshrrev_b32 v24, 6, v0
    v_and_b32 v1, 63, v0
    v_readfirstlane_b32 s24, v24
    s_getpc_b64 s[52:53]
L_pc:
    v_lshlrev_b32 v128, 6, v0
    v_min_u32 v128, L_hot_end-L_pc-4, v128
    v_mov_b32 v129, s53
    v_add_co_u32 v128, vcc, s52, v128
    v_addc_co_u32 v129, vcc, 0, v129, vcc
    global_load_dword v130, v[128:129], off
    s_and_b32 s36, s2, 7
    s_lshl_b32 s36, s36, 4
    s_lshr_b32 s37, s2, 4
    s_add_u32 s36, s36, s37
    s_bfe_u32 s37, s2, 0x10003
    s_lshl_b32 s26, s36, 16
    s_lshl_b32 s38, s36, 18
    s_lshl_b32 s37, s37, 17
    s_add_u32 s38, s38, s37
    s_lshl_b32 s39, s24, 13
    s_add_u32 s25, s38, s39
    s_xor_b32 s44, s25, 65536
    s_add_u32 s31, s25, 4096
    v_and_b32 v30, 15, v1
    v_lshrrev_b32 v31, 4, v1
    v_mul_u32_u24 v2, 0x440, v30
    v_and_b32 v2, 0xf00, v2
    v_lshl_add_u32 v2, v31, 4, v2
    v_lshlrev_b32 v19, 4, v1
    s_and_b32 s41, s24, 3
    s_lshl_b32 s41, s41, 11
    s_add_u32 s42, s26, s41
    s_cmp_ge_u32 s24, 4
    s_cbranch_scc1 L_b
    s_waitcnt lgkmcnt(0)
    s_mov_b32 s8, s4
    s_mov_b32 s9, s5
    s_mov_b32 s10, 0x2000000
    s_mov_b32 s11, 0x00020000
    s_mov_b32 s12, s6
    s_mov_b32 s13, s7
    s_mov_b32 s14, 0x800000
    s_mov_b32 s15, 0x00020000
    s_barrier
    buffer_load_dwordx4 v[64:67], v2, s[8:11], s25 offen offset:0
    buffer_load_dwordx4 v[68:71], v2, s[8:11], s25 offen offset:64
    buffer_load_dwordx4 v[72:75], v2, s[8:11], s25 offen offset:128
    buffer_load_dwordx4 v[76:79], v2, s[8:11], s25 offen offset:192
    buffer_load_dwordx4 v[80:83], v2, s[8:11], s31 offen offset:0
    buffer_load_dwordx4 v[84:87], v2, s[8:11], s31 offen offset:64
    buffer_load_dwordx4 v[88:91], v2, s[8:11], s31 offen offset:128
    buffer_load_dwordx4 v[92:95], v2, s[8:11], s31 offen offset:192
    s_branch L_common
L_b:
    s_waitcnt lgkmcnt(0)
    s_mov_b32 s12, s6
    s_mov_b32 s13, s7
    s_mov_b32 s14, 0x800000
    s_mov_b32 s15, 0x00020000
    s_add_u32 s43, s42, 0
    buffer_load_dwordx4 v[192:195], v19, s[12:15], s43 offen offset:0
    buffer_load_dwordx4 v[196:199], v19, s[12:15], s43 offen offset:1024
    s_barrier
    s_mov_b32 s8, s4
    s_mov_b32 s9, s5
    s_mov_b32 s10, 0x2000000
    s_mov_b32 s11, 0x00020000
L_common:
    s_mov_b32 s16, s32
    s_mov_b32 s17, s33
    s_mov_b32 s18, 0x800000
    s_mov_b32 s19, 0x00020000
    s_mov_b32 s20, s34
    s_mov_b32 s21, s35
    s_mov_b32 s22, 0x2000000
    s_mov_b32 s23, 0x00020000
    s_mov_b32 s48, s4
    s_mov_b32 s49, s5
    s_mov_b32 s50, 0x2000000
    s_mov_b32 s51, 0x00020000
    v_and_b32 v30, 15, v1
    v_lshrrev_b32 v31, 4, v1
    v_xor_b32 v24, v30, v31
    v_lshlrev_b32 v24, 4, v24
    v_lshl_add_u32 v4, v31, 8, v24
    v_xor_b32 v5, 64, v4
    v_lshlrev_b32 v25, 4, v30
    v_lshl_add_u32 v25, v31, 11, v25
    v_add_u32 v6, 65536, v25
    v_xor_b32 v7, 32, v6
    v_xor_b32 v8, 64, v6
    v_xor_b32 v9, 96, v6
    v_lshlrev_b32 v3, 4, v30
    v_lshl_add_u32 v3, v31, 8, v3
    s_lshl_b32 s27, s24, 12
    s_add_u32 s27, s27, 131072
    v_lshrrev_b32 v10, 4, v1
    v_xor_b32 v10, v10, v1
    v_bfe_i32 v10, v10, 1, 1
    v_not_b32 v10, v10
    v_and_b32 v12, 0x3f803f80, v10
    v_and_b32 v13, 0x3f803f80, v10
    v_and_b32 v14, 0x3f803f80, v10
    v_and_b32 v15, 0x3f803f80, v10
    v_bfe_i32 v10, v1, 0, 1
    v_and_b32 v10, 0xaaaaaaaa, v10
    v_or_b32 v10, 0x44444444, v10
    v_and_b32 v31, 7, v1
    s_add_u32 s40, s24, 131068
    v_lshl_add_u32 v30, v31, 12, s40
    v_mov_b32 v31, s27
    v_mov_b32 v29, -1
    ds_write_b32 v31, v29
    s_mov_b32 s28, 0x3e0293ee
    s_mov_b32 s100, 0x2b800000
    s_mov_b32 s29, 0x28000000
    s_mov_b32 s101, 0xffff0000
    s_mov_b32 s30, s25
    s_mov_b32 s45, 0
    s_add_u32 s59, s44, 4096
    s_lshr_b32 s47, s24, 2
    s_add_u32 s47, s47, 1
    s_mov_b32 s92, 0x01010101
    s_lshl_b32 s93, s92, 1
    s_lshl_b32 s94, s92, 2
    s_lshl_b32 s95, s92, 3
    s_lshl_b32 s96, s92, 4
    s_lshl_b32 s97, s92, 5
    s_lshl_b32 s98, s92, 6
    s_lshl_b32 s99, s92, 7
    s_cmp_ge_u32 s24, 4
    s_cbranch_scc1 L_b2
    s_setprio 2
    s_waitcnt lgkmcnt(0)
    s_barrier
    s_branch L_enter
L_b2:
    s_setprio 2
    v_lshrrev_b32 v24, 4, v1
    v_and_b32 v25, 15, v1
    s_and_b32 s40, s24, 1
    s_lshl_b32 s40, s40, 7
    s_and_b32 s43, s41, 4096
    s_add_u32 s40, s40, s43
    v_and_b32 v26, 7, v25
    v_xor_b32 v26, v24, v26
    v_lshlrev_b32 v26, 4, v26
    v_lshl_add_u32 v26, v25, 8, v26
    v_add_u32 v26, s40, v26
    v_xor_b32 v27, 64, v26
    v_lshlrev_b32 v28, 2, v24
    v_xor_b32 v28, v28, v25
    v_lshlrev_b32 v28, 4, v28
    v_lshl_add_u32 v28, v24, 8, v28
    s_lshr_b32 s40, s41, 1
    s_add_u32 s39, s26, s40
    s_add_u32 s40, s41, 65536
    v_mov_b32 v18, s40
    v_bfe_u32 v16, v1, 0, 2
    v_lshl_add_u32 v18, v16, 8, v18
    v_bfe_u32 v16, v1, 4, 1
    v_lshl_add_u32 v18, v16, 10, v18
    v_bfe_u32 v16, v1, 2, 2
    v_lshl_add_u32 v18, v16, 4, v18
    v_bfe_u32 v16, v1, 5, 1
    v_lshl_add_u32 v18, v16, 6, v18
    v_and_b32 v16, 3, v1
    v_lshlrev_b32 v16, 5, v16
    v_xor_b32 v18, v16, v18
    v_lshrrev_b32 v16, 3, v1
    v_and_b32 v16, 4, v16
    v_xor_b32 v16, v16, v25
    v_lshlrev_b32 v16, 4, v16
    v_and_b32 v25, 12, v1
    v_lshl_add_u32 v16, v25, 6, v16
    v_and_b32 v24, 1, v24
    v_lshl_add_u32 v16, v24, 3, v16
    v_add_u32 v16, s40, v16
    v_xor_b32 v17, 128, v16
    s_add_u32 s43, s42, 8192
    buffer_load_dwordx4 v[200:203], v19, s[12:15], s43 offen offset:0
    buffer_load_dwordx4 v[204:207], v19, s[12:15], s43 offen offset:1024
    s_add_u32 m0, s41, 122880
    s_add_u32 s43, s39, 57344
    buffer_load_dwordx4 v28, s[16:19], s43 offen offset:0  lds
    s_add_u32 s43, s39, 60416
    buffer_load_dwordx4 v28, s[16:19], s43 offen offset:1024  lds
    s_add_u32 s43, s42, 16384
    buffer_load_dwordx4 v[208:211], v19, s[12:15], s43 offen offset:0
    buffer_load_dwordx4 v[212:215], v19, s[12:15], s43 offen offset:1024
    s_waitcnt vmcnt(6)
    v_lshlrev_b32 v160, 16, v192
    v_and_b32 v161, s101, v192
    v_lshlrev_b32 v162, 16, v193
    v_and_b32 v163, s101, v193
    v_lshlrev_b32 v164, 16, v194
    v_and_b32 v165, s101, v194
    v_lshlrev_b32 v166, 16, v195
    v_and_b32 v167, s101, v195
    v_mul_f32 v160, s28, v160
    v_mul_f32 v161, s28, v161
    v_mul_f32 v162, s28, v162
    v_mul_f32 v163, s28, v163
    v_mul_f32 v164, s28, v164
    v_mul_f32 v165, s28, v165
    v_mul_f32 v166, s28, v166
    v_mul_f32 v167, s28, v167
    v_cvt_pk_bf16_f32 v192, v160, v161
    v_cvt_pk_bf16_f32 v193, v162, v163
    v_cvt_pk_bf16_f32 v194, v164, v165
    v_cvt_pk_bf16_f32 v195, v166, v167
    ds_write_b128 v26, v[192:195] offset:0
    v_lshlrev_b32 v160, 16, v196
    v_and_b32 v161, s101, v196
    v_lshlrev_b32 v162, 16, v197
    v_and_b32 v163, s101, v197
    v_lshlrev_b32 v164, 16, v198
    v_and_b32 v165, s101, v198
    v_lshlrev_b32 v166, 16, v199
    v_and_b32 v167, s101, v199
    v_mul_f32 v160, s28, v160
    v_mul_f32 v161, s28, v161
    v_mul_f32 v162, s28, v162
    v_mul_f32 v163, s28, v163
    v_mul_f32 v164, s28, v164
    v_mul_f32 v165, s28, v165
    v_mul_f32 v166, s28, v166
    v_mul_f32 v167, s28, v167
    v_cvt_pk_bf16_f32 v196, v160, v161
    v_cvt_pk_bf16_f32 v197, v162, v163
    v_cvt_pk_bf16_f32 v198, v164, v165
    v_cvt_pk_bf16_f32 v199, v166, v167
    ds_write_b128 v27, v[196:199] offset:0
    s_waitcnt lgkmcnt(0)
    s_barrier
    s_add_u32 m0, s41, 114688
    s_add_u32 s43, s39, 49152
    buffer_load_dwordx4 v28, s[16:19], s43 offen offset:0  lds
    s_add_u32 s43, s39, 52224
    buffer_load_dwordx4 v28, s[16:19], s43 offen offset:1024  lds
    s_add_u32 s43, s42, 24576
    buffer_load_dwordx4 v[216:219], v19, s[12:15], s43 offen offset:0
    buffer_load_dwordx4 v[220:223], v19, s[12:15], s43 offen offset:1024
    s_add_u32 m0, s41, 106496
    s_add_u32 s43, s39, 40960
    buffer_load_dwordx4 v28, s[16:19], s43 offen offset:0  lds
    s_add_u32 s43, s39, 44032
    buffer_load_dwordx4 v28, s[16:19], s43 offen offset:1024  lds
    s_waitcnt vmcnt(10)
    v_lshlrev_b32 v160, 16, v200
    v_and_b32 v161, s101, v200
    v_lshlrev_b32 v162, 16, v201
    v_and_b32 v163, s101, v201
    v_lshlrev_b32 v164, 16, v202
    v_and_b32 v165, s101, v202
    v_lshlrev_b32 v166, 16, v203
    v_and_b32 v167, s101, v203
    v_mul_f32 v160, s28, v160
    v_mul_f32 v161, s28, v161
    v_mul_f32 v162, s28, v162
    v_mul_f32 v163, s28, v163
    v_mul_f32 v164, s28, v164
    v_mul_f32 v165, s28, v165
    v_mul_f32 v166, s28, v166
    v_mul_f32 v167, s28, v167
    v_cvt_pk_bf16_f32 v200, v160, v161
    v_cvt_pk_bf16_f32 v201, v162, v163
    v_cvt_pk_bf16_f32 v202, v164, v165
    v_cvt_pk_bf16_f32 v203, v166, v167
    ds_write_b128 v26, v[200:203] offset:8192
    v_lshlrev_b32 v160, 16, v204
    v_and_b32 v161, s101, v204
    v_lshlrev_b32 v162, 16, v205
    v_and_b32 v163, s101, v205
    v_lshlrev_b32 v164, 16, v206
    v_and_b32 v165, s101, v206
    v_lshlrev_b32 v166, 16, v207
    v_and_b32 v167, s101, v207
    v_mul_f32 v160, s28, v160
    v_mul_f32 v161, s28, v161
    v_mul_f32 v162, s28, v162
    v_mul_f32 v163, s28, v163
    v_mul_f32 v164, s28, v164
    v_mul_f32 v165, s28, v165
    v_mul_f32 v166, s28, v166
    v_mul_f32 v167, s28, v167
    v_cvt_pk_bf16_f32 v204, v160, v161
    v_cvt_pk_bf16_f32 v205, v162, v163
    v_cvt_pk_bf16_f32 v206, v164, v165
    v_cvt_pk_bf16_f32 v207, v166, v167
    ds_write_b128 v27, v[204:207] offset:8192
    v_mov_b32 v29, 0xfe
    ds_write_b8 v30, v29
    s_add_u32 m0, s41, 65536
    s_add_u32 s43, s39, 0
    buffer_load_dwordx4 v28, s[16:19], s43 offen offset:0  lds
    s_add_u32 s43, s39, 3072
    buffer_load_dwordx4 v28, s[16:19], s43 offen offset:1024  lds
    s_add_u32 m0, s41, 98304
    s_add_u32 s43, s39, 32768
    buffer_load_dwordx4 v28, s[16:19], s43 offen offset:0  lds
    s_add_u32 s43, s39, 35840
    buffer_load_dwordx4 v28, s[16:19], s43 offen offset:1024  lds
    s_waitcnt vmcnt(10)
    ds_read_b64_tr_b16 v[152:153], v16 offset:57344
    ds_read_b64_tr_b16 v[154:155], v16 offset:58368
    ds_read_b64_tr_b16 v[156:157], v17 offset:57344
    ds_read_b64_tr_b16 v[158:159], v17 offset:58368
    v_lshlrev_b32 v160, 16, v208
    v_and_b32 v161, s101, v208
    v_lshlrev_b32 v162, 16, v209
    v_and_b32 v163, s101, v209
    v_lshlrev_b32 v164, 16, v210
    v_and_b32 v165, s101, v210
    v_lshlrev_b32 v166, 16, v211
    v_and_b32 v167, s101, v211
    v_mul_f32 v160, s28, v160
    v_mul_f32 v161, s28, v161
    v_mul_f32 v162, s28, v162
    v_mul_f32 v163, s28, v163
    v_mul_f32 v164, s28, v164
    v_mul_f32 v165, s28, v165
    v_mul_f32 v166, s28, v166
    v_mul_f32 v167, s28, v167
    v_cvt_pk_bf16_f32 v208, v160, v161
    v_cvt_pk_bf16_f32 v209, v162, v163
    v_cvt_pk_bf16_f32 v210, v164, v165
    v_cvt_pk_bf16_f32 v211, v166, v167
    ds_write_b128 v26, v[208:211] offset:16384
    v_lshlrev_b32 v160, 16, v212
    v_and_b32 v161, s101, v212
    v_lshlrev_b32 v162, 16, v213
    v_and_b32 v163, s101, v213
    v_lshlrev_b32 v164, 16, v214
    v_and_b32 v165, s101, v214
    v_lshlrev_b32 v166, 16, v215
    v_and_b32 v167, s101, v215
    v_mul_f32 v160, s28, v160
    v_mul_f32 v161, s28, v161
    v_mul_f32 v162, s28, v162
    v_mul_f32 v163, s28, v163
    v_mul_f32 v164, s28, v164
    v_mul_f32 v165, s28, v165
    v_mul_f32 v166, s28, v166
    v_mul_f32 v167, s28, v167
    v_cvt_pk_bf16_f32 v212, v160, v161
    v_cvt_pk_bf16_f32 v213, v162, v163
    v_cvt_pk_bf16_f32 v214, v164, v165
    v_cvt_pk_bf16_f32 v215, v166, v167
    ds_write_b128 v27, v[212:215] offset:16384
    s_waitcnt lgkmcnt(2)
    ds_write_b128 v18, v[152:155] offset:57344
    ds_write_b128 v18, v[156:159] offset:57472
    v_mov_b32 v29, 0xfc
    ds_write_b8 v30, v29
    s_add_u32 s43, s42, 32768
    buffer_load_dwordx4 v[224:227], v19, s[12:15], s43 offen offset:0
    buffer_load_dwordx4 v[228:231], v19, s[12:15], s43 offen offset:1024
    s_add_u32 s43, s42, 57344
    buffer_load_dwordx4 v[248:251], v19, s[12:15], s43 offen offset:0
    buffer_load_dwordx4 v[252:255], v19, s[12:15], s43 offen offset:1024
    s_waitcnt vmcnt(10)
    ds_read_b64_tr_b16 v[144:145], v16 offset:49152
    ds_read_b64_tr_b16 v[146:147], v16 offset:50176
    ds_read_b64_tr_b16 v[148:149], v17 offset:49152
    ds_read_b64_tr_b16 v[150:151], v17 offset:50176
    v_lshlrev_b32 v160, 16, v216
    v_and_b32 v161, s101, v216
    v_lshlrev_b32 v162, 16, v217
    v_and_b32 v163, s101, v217
    v_lshlrev_b32 v164, 16, v218
    v_and_b32 v165, s101, v218
    v_lshlrev_b32 v166, 16, v219
    v_and_b32 v167, s101, v219
    v_mul_f32 v160, s28, v160
    v_mul_f32 v161, s28, v161
    v_mul_f32 v162, s28, v162
    v_mul_f32 v163, s28, v163
    v_mul_f32 v164, s28, v164
    v_mul_f32 v165, s28, v165
    v_mul_f32 v166, s28, v166
    v_mul_f32 v167, s28, v167
    v_cvt_pk_bf16_f32 v216, v160, v161
    v_cvt_pk_bf16_f32 v217, v162, v163
    v_cvt_pk_bf16_f32 v218, v164, v165
    v_cvt_pk_bf16_f32 v219, v166, v167
    ds_write_b128 v26, v[216:219] offset:24576
    v_lshlrev_b32 v160, 16, v220
    v_and_b32 v161, s101, v220
    v_lshlrev_b32 v162, 16, v221
    v_and_b32 v163, s101, v221
    v_lshlrev_b32 v164, 16, v222
    v_and_b32 v165, s101, v222
    v_lshlrev_b32 v166, 16, v223
    v_and_b32 v167, s101, v223
    v_mul_f32 v160, s28, v160
    v_mul_f32 v161, s28, v161
    v_mul_f32 v162, s28, v162
    v_mul_f32 v163, s28, v163
    v_mul_f32 v164, s28, v164
    v_mul_f32 v165, s28, v165
    v_mul_f32 v166, s28, v166
    v_mul_f32 v167, s28, v167
    v_cvt_pk_bf16_f32 v220, v160, v161
    v_cvt_pk_bf16_f32 v221, v162, v163
    v_cvt_pk_bf16_f32 v222, v164, v165
    v_cvt_pk_bf16_f32 v223, v166, v167
    ds_write_b128 v27, v[220:223] offset:24576
    s_waitcnt lgkmcnt(2)
    ds_write_b128 v18, v[144:147] offset:49152
    ds_write_b128 v18, v[148:151] offset:49280
    v_mov_b32 v29, 0xf8
    ds_write_b8 v30, v29
    s_add_u32 m0, s41, 73728
    s_add_u32 s43, s39, 8192
    buffer_load_dwordx4 v28, s[16:19], s43 offen offset:0  lds
    s_add_u32 s43, s39, 11264
    buffer_load_dwordx4 v28, s[16:19], s43 offen offset:1024  lds
    s_add_u32 m0, s41, 90112
    s_add_u32 s43, s39, 24576
    buffer_load_dwordx4 v28, s[16:19], s43 offen offset:0  lds
    s_add_u32 s43, s39, 27648
    buffer_load_dwordx4 v28, s[16:19], s43 offen offset:1024  lds
    s_waitcnt vmcnt(10)
    ds_read_b64_tr_b16 v[136:137], v16 offset:40960
    ds_read_b64_tr_b16 v[138:139], v16 offset:41984
    ds_read_b64_tr_b16 v[140:141], v17 offset:40960
    ds_read_b64_tr_b16 v[142:143], v17 offset:41984
    ds_read_b64_tr_b16 v[128:129], v16 offset:0
    ds_read_b64_tr_b16 v[130:131], v16 offset:1024
    ds_read_b64_tr_b16 v[132:133], v17 offset:0
    ds_read_b64_tr_b16 v[134:135], v17 offset:1024
    s_waitcnt lgkmcnt(0)
    ds_write_b128 v18, v[136:139] offset:40960
    ds_write_b128 v18, v[140:143] offset:41088
    ds_write_b128 v18, v[128:131] offset:0
    ds_write_b128 v18, v[132:135] offset:128
    v_mov_b32 v29, 0xf0
    ds_write_b8 v30, v29
    s_add_u32 s43, s42, 40960
    buffer_load_dwordx4 v[232:235], v19, s[12:15], s43 offen offset:0
    buffer_load_dwordx4 v[236:239], v19, s[12:15], s43 offen offset:1024
    s_add_u32 s43, s42, 49152
    buffer_load_dwordx4 v[240:243], v19, s[12:15], s43 offen offset:0
    buffer_load_dwordx4 v[244:247], v19, s[12:15], s43 offen offset:1024
    s_waitcnt vmcnt(10)
    ds_read_b64_tr_b16 v[128:129], v16 offset:32768
    ds_read_b64_tr_b16 v[130:131], v16 offset:33792
    ds_read_b64_tr_b16 v[132:133], v17 offset:32768
    ds_read_b64_tr_b16 v[134:135], v17 offset:33792
    v_lshlrev_b32 v160, 16, v224
    v_and_b32 v161, s101, v224
    v_lshlrev_b32 v162, 16, v225
    v_and_b32 v163, s101, v225
    v_lshlrev_b32 v164, 16, v226
    v_and_b32 v165, s101, v226
    v_lshlrev_b32 v166, 16, v227
    v_and_b32 v167, s101, v227
    v_mul_f32 v160, s28, v160
    v_mul_f32 v161, s28, v161
    v_mul_f32 v162, s28, v162
    v_mul_f32 v163, s28, v163
    v_mul_f32 v164, s28, v164
    v_mul_f32 v165, s28, v165
    v_mul_f32 v166, s28, v166
    v_mul_f32 v167, s28, v167
    v_cvt_pk_bf16_f32 v224, v160, v161
    v_cvt_pk_bf16_f32 v225, v162, v163
    v_cvt_pk_bf16_f32 v226, v164, v165
    v_cvt_pk_bf16_f32 v227, v166, v167
    ds_write_b128 v26, v[224:227] offset:32768
    v_lshlrev_b32 v160, 16, v228
    v_and_b32 v161, s101, v228
    v_lshlrev_b32 v162, 16, v229
    v_and_b32 v163, s101, v229
    v_lshlrev_b32 v164, 16, v230
    v_and_b32 v165, s101, v230
    v_lshlrev_b32 v166, 16, v231
    v_and_b32 v167, s101, v231
    v_mul_f32 v160, s28, v160
    v_mul_f32 v161, s28, v161
    v_mul_f32 v162, s28, v162
    v_mul_f32 v163, s28, v163
    v_mul_f32 v164, s28, v164
    v_mul_f32 v165, s28, v165
    v_mul_f32 v166, s28, v166
    v_mul_f32 v167, s28, v167
    v_cvt_pk_bf16_f32 v228, v160, v161
    v_cvt_pk_bf16_f32 v229, v162, v163
    v_cvt_pk_bf16_f32 v230, v164, v165
    v_cvt_pk_bf16_f32 v231, v166, v167
    ds_write_b128 v27, v[228:231] offset:32768
    s_waitcnt lgkmcnt(2)
    ds_write_b128 v18, v[128:131] offset:32768
    ds_write_b128 v18, v[132:135] offset:32896
    v_mov_b32 v29, 0xe0
    ds_write_b8 v30, v29
    s_add_u32 m0, s41, 81920
    s_add_u32 s43, s39, 16384
    buffer_load_dwordx4 v28, s[16:19], s43 offen offset:0  lds
    s_add_u32 s43, s39, 19456
    buffer_load_dwordx4 v28, s[16:19], s43 offen offset:1024  lds
    buffer_load_dwordx4 v[64:67], v2, s[8:11], s25 offen offset:0
    buffer_load_dwordx4 v[68:71], v2, s[8:11], s25 offen offset:64
    s_waitcnt vmcnt(10)
    ds_read_b64_tr_b16 v[136:137], v16 offset:8192
    ds_read_b64_tr_b16 v[138:139], v16 offset:9216
    ds_read_b64_tr_b16 v[140:141], v17 offset:8192
    ds_read_b64_tr_b16 v[142:143], v17 offset:9216
    v_lshlrev_b32 v160, 16, v248
    v_and_b32 v161, s101, v248
    v_lshlrev_b32 v162, 16, v249
    v_and_b32 v163, s101, v249
    v_lshlrev_b32 v164, 16, v250
    v_and_b32 v165, s101, v250
    v_lshlrev_b32 v166, 16, v251
    v_and_b32 v167, s101, v251
    v_mul_f32 v160, s28, v160
    v_mul_f32 v161, s28, v161
    v_mul_f32 v162, s28, v162
    v_mul_f32 v163, s28, v163
    v_mul_f32 v164, s28, v164
    v_mul_f32 v165, s28, v165
    v_mul_f32 v166, s28, v166
    v_mul_f32 v167, s28, v167
    v_cvt_pk_bf16_f32 v248, v160, v161
    v_cvt_pk_bf16_f32 v249, v162, v163
    v_cvt_pk_bf16_f32 v250, v164, v165
    v_cvt_pk_bf16_f32 v251, v166, v167
    ds_write_b128 v26, v[248:251] offset:57344
    v_lshlrev_b32 v160, 16, v252
    v_and_b32 v161, s101, v252
    v_lshlrev_b32 v162, 16, v253
    v_and_b32 v163, s101, v253
    v_lshlrev_b32 v164, 16, v254
    v_and_b32 v165, s101, v254
    v_lshlrev_b32 v166, 16, v255
    v_and_b32 v167, s101, v255
    v_mul_f32 v160, s28, v160
    v_mul_f32 v161, s28, v161
    v_mul_f32 v162, s28, v162
    v_mul_f32 v163, s28, v163
    v_mul_f32 v164, s28, v164
    v_mul_f32 v165, s28, v165
    v_mul_f32 v166, s28, v166
    v_mul_f32 v167, s28, v167
    v_cvt_pk_bf16_f32 v252, v160, v161
    v_cvt_pk_bf16_f32 v253, v162, v163
    v_cvt_pk_bf16_f32 v254, v164, v165
    v_cvt_pk_bf16_f32 v255, v166, v167
    ds_write_b128 v27, v[252:255] offset:57344
    s_waitcnt lgkmcnt(2)
    ds_write_b128 v18, v[136:139] offset:8192
    ds_write_b128 v18, v[140:143] offset:8320
    v_mov_b32 v29, 0xc0
    ds_write_b8 v30, v29
    buffer_load_dwordx4 v[72:75], v2, s[8:11], s25 offen offset:128
    buffer_load_dwordx4 v[76:79], v2, s[8:11], s25 offen offset:192
    buffer_load_dwordx4 v[80:83], v2, s[8:11], s31 offen offset:0
    buffer_load_dwordx4 v[84:87], v2, s[8:11], s31 offen offset:64
    s_waitcnt vmcnt(10)
    ds_read_b64_tr_b16 v[152:153], v16 offset:24576
    ds_read_b64_tr_b16 v[154:155], v16 offset:25600
    ds_read_b64_tr_b16 v[156:157], v17 offset:24576
    ds_read_b64_tr_b16 v[158:159], v17 offset:25600
    v_lshlrev_b32 v160, 16, v232
    v_and_b32 v161, s101, v232
    v_lshlrev_b32 v162, 16, v233
    v_and_b32 v163, s101, v233
    v_lshlrev_b32 v164, 16, v234
    v_and_b32 v165, s101, v234
    v_lshlrev_b32 v166, 16, v235
    v_and_b32 v167, s101, v235
    v_mul_f32 v160, s28, v160
    v_mul_f32 v161, s28, v161
    v_mul_f32 v162, s28, v162
    v_mul_f32 v163, s28, v163
    v_mul_f32 v164, s28, v164
    v_mul_f32 v165, s28, v165
    v_mul_f32 v166, s28, v166
    v_mul_f32 v167, s28, v167
    v_cvt_pk_bf16_f32 v232, v160, v161
    v_cvt_pk_bf16_f32 v233, v162, v163
    v_cvt_pk_bf16_f32 v234, v164, v165
    v_cvt_pk_bf16_f32 v235, v166, v167
    ds_write_b128 v26, v[232:235] offset:40960
    v_lshlrev_b32 v160, 16, v236
    v_and_b32 v161, s101, v236
    v_lshlrev_b32 v162, 16, v237
    v_and_b32 v163, s101, v237
    v_lshlrev_b32 v164, 16, v238
    v_and_b32 v165, s101, v238
    v_lshlrev_b32 v166, 16, v239
    v_and_b32 v167, s101, v239
    v_mul_f32 v160, s28, v160
    v_mul_f32 v161, s28, v161
    v_mul_f32 v162, s28, v162
    v_mul_f32 v163, s28, v163
    v_mul_f32 v164, s28, v164
    v_mul_f32 v165, s28, v165
    v_mul_f32 v166, s28, v166
    v_mul_f32 v167, s28, v167
    v_cvt_pk_bf16_f32 v236, v160, v161
    v_cvt_pk_bf16_f32 v237, v162, v163
    v_cvt_pk_bf16_f32 v238, v164, v165
    v_cvt_pk_bf16_f32 v239, v166, v167
    ds_write_b128 v27, v[236:239] offset:40960
    s_waitcnt lgkmcnt(2)
    ds_write_b128 v18, v[152:155] offset:24576
    ds_write_b128 v18, v[156:159] offset:24704
    v_mov_b32 v29, 0x80
    ds_write_b8 v30, v29
    buffer_load_dwordx4 v[88:91], v2, s[8:11], s31 offen offset:128
    buffer_load_dwordx4 v[92:95], v2, s[8:11], s31 offen offset:192
    s_waitcnt vmcnt(8)
    ds_read_b64_tr_b16 v[144:145], v16 offset:16384
    ds_read_b64_tr_b16 v[146:147], v16 offset:17408
    ds_read_b64_tr_b16 v[148:149], v17 offset:16384
    ds_read_b64_tr_b16 v[150:151], v17 offset:17408
    v_lshlrev_b32 v160, 16, v240
    v_and_b32 v161, s101, v240
    v_lshlrev_b32 v162, 16, v241
    v_and_b32 v163, s101, v241
    v_lshlrev_b32 v164, 16, v242
    v_and_b32 v165, s101, v242
    v_lshlrev_b32 v166, 16, v243
    v_and_b32 v167, s101, v243
    v_mul_f32 v160, s28, v160
    v_mul_f32 v161, s28, v161
    v_mul_f32 v162, s28, v162
    v_mul_f32 v163, s28, v163
    v_mul_f32 v164, s28, v164
    v_mul_f32 v165, s28, v165
    v_mul_f32 v166, s28, v166
    v_mul_f32 v167, s28, v167
    v_cvt_pk_bf16_f32 v240, v160, v161
    v_cvt_pk_bf16_f32 v241, v162, v163
    v_cvt_pk_bf16_f32 v242, v164, v165
    v_cvt_pk_bf16_f32 v243, v166, v167
    ds_write_b128 v26, v[240:243] offset:49152
    v_lshlrev_b32 v160, 16, v244
    v_and_b32 v161, s101, v244
    v_lshlrev_b32 v162, 16, v245
    v_and_b32 v163, s101, v245
    v_lshlrev_b32 v164, 16, v246
    v_and_b32 v165, s101, v246
    v_lshlrev_b32 v166, 16, v247
    v_and_b32 v167, s101, v247
    v_mul_f32 v160, s28, v160
    v_mul_f32 v161, s28, v161
    v_mul_f32 v162, s28, v162
    v_mul_f32 v163, s28, v163
    v_mul_f32 v164, s28, v164
    v_mul_f32 v165, s28, v165
    v_mul_f32 v166, s28, v166
    v_mul_f32 v167, s28, v167
    v_cvt_pk_bf16_f32 v244, v160, v161
    v_cvt_pk_bf16_f32 v245, v162, v163
    v_cvt_pk_bf16_f32 v246, v164, v165
    v_cvt_pk_bf16_f32 v247, v166, v167
    ds_write_b128 v27, v[244:247] offset:49152
    s_waitcnt lgkmcnt(2)
    ds_write_b128 v18, v[144:147] offset:16384
    ds_write_b128 v18, v[148:151] offset:16512
    v_mov_b32 v29, 0x0
    ds_write_b8 v30, v29
    s_setprio 1
    s_waitcnt vmcnt(0)
L_bw:
    ds_read_b32 v29, v31
    s_waitcnt lgkmcnt(0)
    v_readfirstlane_b32 s46, v29
    s_cmp_lg_u32 s46, 0
    s_cbranch_scc1 L_bw
    s_mov_b64 vcc, 0
    s_branch L_ent2
L_enter:
    s_mov_b64 vcc, 1
    s_mov_b32 s46, -1
L_ent2:
    ds_read_b128 v[32:35], v4 offset:0
    ds_read_b128 v[36:39], v4 offset:4096
    ds_read_b128 v[40:43], v5 offset:1024
    ds_read_b128 v[44:47], v5 offset:5120
    ds_read_b128 v[48:51], v4 offset:2048
    ds_read_b128 v[52:55], v4 offset:6144
    ds_read_b128 v[56:59], v5 offset:3072
    ds_read_b128 v[60:63], v5 offset:7168
    v_mov_b64 v[16:17], 0
    v_mov_b64 v[18:19], 0
    s_waitcnt vmcnt(0)
    s_cmp_eq_u32 s45, 1
L_bodyB:
    s_waitcnt lgkmcnt(6)
    v_mfma_f32_16x16x32_bf16 v[128:131], v[32:35], v[64:67], 0
    s_cbranch_vccnz L_chk0
L_back0:
    v_mfma_f32_16x16x32_bf16 v[136:139], v[32:35], v[80:83], 0
    ds_read_b128 v[32:35], v4 offset:8192
    v_mfma_f32_16x16x32_bf16 v[132:135], v[36:39], v[64:67], 0
    v_mfma_f32_16x16x32_bf16 v[140:143], v[36:39], v[80:83], 0
    s_waitcnt lgkmcnt(5)
    ds_read_b128 v[36:39], v4 offset:12288
    v_mfma_f32_16x16x32_bf16 v[128:131], v[40:43], v[68:71], v[128:131]
    v_mfma_f32_16x16x32_bf16 v[136:139], v[40:43], v[84:87], v[136:139]
    ds_read_b128 v[40:43], v5 offset:9216
    v_mfma_f32_16x16x32_bf16 v[132:135], v[44:47], v[68:71], v[132:135]
    v_mfma_f32_16x16x32_bf16 v[140:143], v[44:47], v[84:87], v[140:143]
    s_waitcnt lgkmcnt(5)
    ds_read_b128 v[44:47], v5 offset:13312
    v_mfma_f32_16x16x32_bf16 v[128:131], v[48:51], v[72:75], v[128:131]
    v_mfma_f32_16x16x32_bf16 v[136:139], v[48:51], v[88:91], v[136:139]
    ds_read_b128 v[48:51], v4 offset:10240
    v_mfma_f32_16x16x32_bf16 v[132:135], v[52:55], v[72:75], v[132:135]
    v_mfma_f32_16x16x32_bf16 v[140:143], v[52:55], v[88:91], v[140:143]
    s_waitcnt lgkmcnt(5)
    ds_read_b128 v[52:55], v4 offset:14336
    v_mfma_f32_16x16x32_bf16 v[128:131], v[56:59], v[76:79], v[128:131]
    s_cbranch_vccnz L_chk1
L_back1:
    v_mfma_f32_16x16x32_bf16 v[136:139], v[56:59], v[92:95], v[136:139]
    ds_read_b128 v[56:59], v5 offset:11264
    v_mfma_f32_16x16x32_bf16 v[132:135], v[60:63], v[76:79], v[132:135]
    v_mfma_f32_16x16x32_bf16 v[140:143], v[60:63], v[92:95], v[140:143]
    s_waitcnt lgkmcnt(5)
    ds_read_b128 v[60:63], v5 offset:15360
    v_mfma_f32_16x16x32_bf16 v[144:147], v[32:35], v[64:67], 0
    v_exp_f32 v128, v128
    v_mfma_f32_16x16x32_bf16 v[152:155], v[32:35], v[80:83], 0
    v_exp_f32 v129, v129
    v_mfma_f32_16x16x32_bf16 v[148:151], v[36:39], v[64:67], 0
    ds_read_b128 v[32:35], v4 offset:16384
    v_cvt_pk_bf16_f32 v128, v128, v129
    v_mfma_f32_16x16x32_bf16 v[156:159], v[36:39], v[80:83], 0
    s_waitcnt lgkmcnt(5)
    v_exp_f32 v130, v130
    v_mfma_f32_16x16x32_bf16 v[144:147], v[40:43], v[68:71], v[144:147]
    v_exp_f32 v131, v131
    v_mfma_f32_16x16x32_bf16 v[152:155], v[40:43], v[84:87], v[152:155]
    ds_read_b128 v[36:39], v4 offset:20480
    v_cvt_pk_bf16_f32 v129, v130, v131
    v_mfma_f32_16x16x32_bf16 v[148:151], v[44:47], v[68:71], v[148:151]
    v_exp_f32 v132, v132
    v_mfma_f32_16x16x32_bf16 v[156:159], v[44:47], v[84:87], v[156:159]
    s_waitcnt lgkmcnt(4)
    ds_read_b128 v[40:43], v5 offset:17408
    ds_read_b128 v[44:47], v5 offset:21504
    v_mfma_f32_16x16x32_bf16 v[144:147], v[48:51], v[72:75], v[144:147]
    v_exp_f32 v133, v133
    v_mfma_f32_16x16x32_bf16 v[152:155], v[48:51], v[88:91], v[152:155]
    ds_read_b128 v[48:51], v4 offset:18432
    v_cvt_pk_bf16_f32 v130, v132, v133
    v_mfma_f32_16x16x32_bf16 v[148:151], v[52:55], v[72:75], v[148:151]
    v_exp_f32 v134, v134
    v_mfma_f32_16x16x32_bf16 v[156:159], v[52:55], v[88:91], v[156:159]
    s_waitcnt lgkmcnt(5)
    v_exp_f32 v135, v135
    v_mfma_f32_16x16x32_bf16 v[144:147], v[56:59], v[76:79], v[144:147]
    ds_read_b128 v[52:55], v4 offset:22528
    v_cvt_pk_bf16_f32 v131, v134, v135
    v_mfma_f32_16x16x32_bf16 v[152:155], v[56:59], v[92:95], v[152:155]
    s_cbranch_vccnz L_chk2
L_back2:
    v_exp_f32 v136, v136
    v_mfma_f32_16x16x32_bf16 v[148:151], v[60:63], v[76:79], v[148:151]
    v_exp_f32 v137, v137
    v_mfma_f32_16x16x32_bf16 v[156:159], v[60:63], v[92:95], v[156:159]
    s_waitcnt lgkmcnt(4)
    ds_read_b128 v[56:59], v5 offset:19456
    v_cvt_pk_bf16_f32 v132, v136, v137
    v_mfma_f32_16x16x32_bf16 v[160:163], v[32:35], v[64:67], 0
    s_setprio 2
    v_exp_f32 v138, v138
    v_mfma_f32_16x16x32_bf16 v[168:171], v[32:35], v[80:83], 0
    ds_read_b128 v[60:63], v5 offset:23552
    ds_read_b128 v[32:35], v4 offset:24576
    v_mfma_f32_16x16x32_bf16 v[164:167], v[36:39], v[64:67], 0
    v_exp_f32 v139, v139
    v_mfma_f32_16x16x32_bf16 v[172:175], v[36:39], v[80:83], 0
    s_waitcnt lgkmcnt(5)
    ds_read_b128 v[36:39], v4 offset:28672
    v_cvt_pk_bf16_f32 v133, v138, v139
    v_mfma_f32_16x16x32_bf16 v[160:163], v[40:43], v[68:71], v[160:163]
    v_exp_f32 v140, v140
    v_mfma_f32_16x16x32_bf16 v[168:171], v[40:43], v[84:87], v[168:171]
    v_exp_f32 v141, v141
    v_mfma_f32_16x16x32_bf16 v[164:167], v[44:47], v[68:71], v[164:167]
    ds_read_b128 v[40:43], v5 offset:25600
    v_cvt_pk_bf16_f32 v134, v140, v141
    v_mfma_f32_16x16x32_bf16 v[172:175], v[44:47], v[84:87], v[172:175]
    s_waitcnt lgkmcnt(5)
    v_exp_f32 v142, v142
    v_mfma_f32_16x16x32_bf16 v[160:163], v[48:51], v[72:75], v[160:163]
    v_exp_f32 v143, v143
    v_mfma_f32_16x16x32_bf16 v[168:171], v[48:51], v[88:91], v[168:171]
    ds_read_b128 v[44:47], v5 offset:29696
    v_cvt_pk_bf16_f32 v135, v142, v143
    v_mfma_f32_16x16x32_bf16 v[164:167], v[52:55], v[72:75], v[164:167]
    v_exp_f32 v144, v144
    v_mfma_f32_16x16x32_bf16 v[172:175], v[52:55], v[88:91], v[172:175]
    ds_read_b128 v[48:51], v4 offset:26624
    ds_read_b128 v[52:55], v4 offset:30720
    v_smfmac_f32_16x16x64_bf16 v[16:19], v[12:15], v[128:135], v10
    s_waitcnt lgkmcnt(6)
    v_exp_f32 v145, v145
    v_mfma_f32_16x16x32_bf16 v[160:163], v[56:59], v[76:79], v[160:163]
    s_cbranch_vccnz L_chk3
L_back3:
    v_exp_f32 v146, v146
    v_mfma_f32_16x16x32_bf16 v[168:171], v[56:59], v[92:95], v[168:171]
    ds_read_b128 v[56:59], v5 offset:27648
    v_cvt_pk_bf16_f32 v144, v144, v145
    v_mfma_f32_16x16x32_bf16 v[164:167], v[60:63], v[76:79], v[164:167]
    v_exp_f32 v147, v147
    v_mfma_f32_16x16x32_bf16 v[172:175], v[60:63], v[92:95], v[172:175]
    s_waitcnt lgkmcnt(5)
    ds_read_b128 v[60:63], v5 offset:31744
    v_cvt_pk_bf16_f32 v145, v146, v147
    v_mfma_f32_16x16x32_bf16 v[176:179], v[32:35], v[64:67], 0
    v_exp_f32 v148, v148
    v_mfma_f32_16x16x32_bf16 v[184:187], v[32:35], v[80:83], 0
    v_exp_f32 v149, v149
    v_mfma_f32_16x16x32_bf16 v[180:183], v[36:39], v[64:67], 0
    ds_read_b128 v[32:35], v6 offset:0
    v_cvt_pk_bf16_f32 v146, v148, v149
    v_mfma_f32_16x16x32_bf16 v[188:191], v[36:39], v[80:83], 0
    s_waitcnt lgkmcnt(5)
    v_exp_f32 v150, v150
    v_mfma_f32_16x16x32_bf16 v[176:179], v[40:43], v[68:71], v[176:179]
    v_exp_f32 v151, v151
    v_mfma_f32_16x16x32_bf16 v[184:187], v[40:43], v[84:87], v[184:187]
    ds_read_b128 v[36:39], v7 offset:256
    v_cvt_pk_bf16_f32 v147, v150, v151
    v_mfma_f32_16x16x32_bf16 v[180:183], v[44:47], v[68:71], v[180:183]
    v_exp_f32 v152, v152
    v_mfma_f32_16x16x32_bf16 v[188:191], v[44:47], v[84:87], v[188:191]
    s_waitcnt lgkmcnt(4)
    ds_read_b128 v[40:43], v8 offset:512
    ds_read_b128 v[44:47], v9 offset:768
    v_mfma_f32_16x16x32_bf16 v[176:179], v[48:51], v[72:75], v[176:179]
    v_exp_f32 v153, v153
    v_mfma_f32_16x16x32_bf16 v[184:187], v[48:51], v[88:91], v[184:187]
    ds_read_b128 v[48:51], v6 offset:1024
    v_cvt_pk_bf16_f32 v148, v152, v153
    v_mfma_f32_16x16x32_bf16 v[180:183], v[52:55], v[72:75], v[180:183]
    v_exp_f32 v154, v154
    v_mfma_f32_16x16x32_bf16 v[188:191], v[52:55], v[88:91], v[188:191]
    s_waitcnt lgkmcnt(5)
    v_exp_f32 v155, v155
    v_mfma_f32_16x16x32_bf16 v[176:179], v[56:59], v[76:79], v[176:179]
    ds_read_b128 v[52:55], v7 offset:1280
    v_cvt_pk_bf16_f32 v149, v154, v155
    v_mfma_f32_16x16x32_bf16 v[184:187], v[56:59], v[92:95], v[184:187]
    s_cbranch_vccnz L_chk4
L_back4:
    v_exp_f32 v156, v156
    v_mfma_f32_16x16x32_bf16 v[180:183], v[60:63], v[76:79], v[180:183]
    v_exp_f32 v157, v157
    v_mfma_f32_16x16x32_bf16 v[188:191], v[60:63], v[92:95], v[188:191]
    s_waitcnt lgkmcnt(4)
    ds_read_b128 v[56:59], v8 offset:1536
    v_cvt_pk_bf16_f32 v150, v156, v157
    v_mfma_f32_16x16x32_bf16 v[192:195], v[128:131], v[32:35], 0
    v_exp_f32 v158, v158
    v_mfma_f32_16x16x32_bf16 v[200:203], v[132:135], v[32:35], 0
    ds_read_b128 v[60:63], v9 offset:1792
    ds_read_b128 v[32:35], v4 offset:32768
    v_mfma_f32_16x16x32_bf16 v[196:199], v[128:131], v[36:39], 0
    v_exp_f32 v159, v159
    v_mfma_f32_16x16x32_bf16 v[204:207], v[132:135], v[36:39], 0
    s_waitcnt lgkmcnt(5)
    ds_read_b128 v[36:39], v4 offset:36864
    v_cvt_pk_bf16_f32 v151, v158, v159
    v_mfma_f32_16x16x32_bf16 v[208:211], v[128:131], v[40:43], 0
    v_exp_f32 v160, v160
    v_mfma_f32_16x16x32_bf16 v[216:219], v[132:135], v[40:43], 0
    v_exp_f32 v161, v161
    v_smfmac_f32_16x16x64_bf16 v[16:19], v[12:15], v[144:151], v10
    ds_read_b128 v[40:43], v5 offset:33792
    v_cvt_pk_bf16_f32 v160, v160, v161
    v_mfma_f32_16x16x32_bf16 v[212:215], v[128:131], v[44:47], 0
    v_exp_f32 v162, v162
    v_mfma_f32_16x16x32_bf16 v[220:223], v[132:135], v[44:47], 0
    s_waitcnt lgkmcnt(5)
    v_exp_f32 v163, v163
    v_mfma_f32_16x16x32_bf16 v[224:227], v[128:131], v[48:51], 0
    ds_read_b128 v[44:47], v5 offset:37888
    v_cvt_pk_bf16_f32 v161, v162, v163
    v_mfma_f32_16x16x32_bf16 v[232:235], v[132:135], v[48:51], 0
    v_exp_f32 v164, v164
    v_mfma_f32_16x16x32_bf16 v[228:231], v[128:131], v[52:55], 0
    v_exp_f32 v165, v165
    v_mfma_f32_16x16x32_bf16 v[236:239], v[132:135], v[52:55], 0
    s_waitcnt lgkmcnt(4)
    ds_read_b128 v[48:51], v4 offset:34816
    v_cvt_pk_bf16_f32 v162, v164, v165
    v_mfma_f32_16x16x32_bf16 v[240:243], v[128:131], v[56:59], 0
    s_cbranch_vccnz L_chk5
L_back5:
    v_exp_f32 v166, v166
    v_mfma_f32_16x16x32_bf16 v[248:251], v[132:135], v[56:59], 0
    ds_read_b128 v[52:55], v4 offset:38912
    ds_read_b128 v[56:59], v5 offset:35840
    v_mfma_f32_16x16x32_bf16 v[244:247], v[128:131], v[60:63], 0
    v_exp_f32 v167, v167
    v_mfma_f32_16x16x32_bf16 v[252:255], v[132:135], v[60:63], 0
    s_waitcnt lgkmcnt(5)
    ds_read_b128 v[60:63], v5 offset:39936
    v_cvt_pk_bf16_f32 v163, v166, v167
    v_mfma_f32_16x16x32_bf16 v[128:131], v[32:35], v[64:67], 0
    v_exp_f32 v168, v168
    v_mfma_f32_16x16x32_bf16 v[136:139], v[32:35], v[80:83], 0
    v_exp_f32 v169, v169
    v_mfma_f32_16x16x32_bf16 v[132:135], v[36:39], v[64:67], 0
    ds_read_b128 v[32:35], v6 offset:8192
    v_cvt_pk_bf16_f32 v164, v168, v169
    v_mfma_f32_16x16x32_bf16 v[140:143], v[36:39], v[80:83], 0
    s_waitcnt lgkmcnt(5)
    v_exp_f32 v170, v170
    v_mfma_f32_16x16x32_bf16 v[128:131], v[40:43], v[68:71], v[128:131]
    v_exp_f32 v171, v171
    v_mfma_f32_16x16x32_bf16 v[136:139], v[40:43], v[84:87], v[136:139]
    ds_read_b128 v[36:39], v7 offset:8448
    v_cvt_pk_bf16_f32 v165, v170, v171
    v_mfma_f32_16x16x32_bf16 v[132:135], v[44:47], v[68:71], v[132:135]
    v_exp_f32 v172, v172
    v_mfma_f32_16x16x32_bf16 v[140:143], v[44:47], v[84:87], v[140:143]
    s_waitcnt lgkmcnt(4)
    ds_read_b128 v[40:43], v8 offset:8704
    ds_read_b128 v[44:47], v9 offset:8960
    v_mfma_f32_16x16x32_bf16 v[128:131], v[48:51], v[72:75], v[128:131]
    v_exp_f32 v173, v173
    v_mfma_f32_16x16x32_bf16 v[136:139], v[48:51], v[88:91], v[136:139]
    ds_read_b128 v[48:51], v6 offset:9216
    v_cvt_pk_bf16_f32 v166, v172, v173
    v_mfma_f32_16x16x32_bf16 v[132:135], v[52:55], v[72:75], v[132:135]
    v_exp_f32 v174, v174
    v_mfma_f32_16x16x32_bf16 v[140:143], v[52:55], v[88:91], v[140:143]
    s_waitcnt lgkmcnt(5)
    v_exp_f32 v175, v175
    v_mfma_f32_16x16x32_bf16 v[128:131], v[56:59], v[76:79], v[128:131]
    ds_read_b128 v[52:55], v7 offset:9472
    v_cvt_pk_bf16_f32 v167, v174, v175
    v_mfma_f32_16x16x32_bf16 v[136:139], v[56:59], v[92:95], v[136:139]
    s_cbranch_vccnz L_chk6
L_back6:
    v_exp_f32 v176, v176
    v_mfma_f32_16x16x32_bf16 v[132:135], v[60:63], v[76:79], v[132:135]
    v_exp_f32 v177, v177
    v_smfmac_f32_16x16x64_bf16 v[16:19], v[12:15], v[160:167], v10
    ds_read_b128 v[56:59], v8 offset:9728
    v_cvt_pk_bf16_f32 v176, v176, v177
    v_mfma_f32_16x16x32_bf16 v[140:143], v[60:63], v[92:95], v[140:143]
    s_waitcnt lgkmcnt(5)
    v_exp_f32 v178, v178
    v_mfma_f32_16x16x32_bf16 v[192:195], v[144:147], v[32:35], v[192:195]
    v_exp_f32 v179, v179
    v_mfma_f32_16x16x32_bf16 v[200:203], v[148:151], v[32:35], v[200:203]
    ds_read_b128 v[60:63], v9 offset:9984
    v_cvt_pk_bf16_f32 v177, v178, v179
    v_mfma_f32_16x16x32_bf16 v[196:199], v[144:147], v[36:39], v[196:199]
    v_exp_f32 v180, v180
    v_mfma_f32_16x16x32_bf16 v[204:207], v[148:151], v[36:39], v[204:207]
    s_waitcnt lgkmcnt(4)
    ds_read_b128 v[32:35], v4 offset:40960
    ds_read_b128 v[36:39], v4 offset:45056
    v_mfma_f32_16x16x32_bf16 v[208:211], v[144:147], v[40:43], v[208:211]
    v_exp_f32 v181, v181
    v_mfma_f32_16x16x32_bf16 v[216:219], v[148:151], v[40:43], v[216:219]
    ds_read_b128 v[40:43], v5 offset:41984
    v_cvt_pk_bf16_f32 v178, v180, v181
    v_mfma_f32_16x16x32_bf16 v[212:215], v[144:147], v[44:47], v[212:215]
    v_exp_f32 v182, v182
    v_mfma_f32_16x16x32_bf16 v[220:223], v[148:151], v[44:47], v[220:223]
    s_waitcnt lgkmcnt(5)
    v_exp_f32 v183, v183
    v_mfma_f32_16x16x32_bf16 v[224:227], v[144:147], v[48:51], v[224:227]
    ds_read_b128 v[44:47], v5 offset:46080
    v_cvt_pk_bf16_f32 v179, v182, v183
    v_mfma_f32_16x16x32_bf16 v[232:235], v[148:151], v[48:51], v[232:235]
    v_exp_f32 v184, v184
    v_mfma_f32_16x16x32_bf16 v[228:231], v[144:147], v[52:55], v[228:231]
    v_exp_f32 v185, v185
    v_mfma_f32_16x16x32_bf16 v[236:239], v[148:151], v[52:55], v[236:239]
    s_waitcnt lgkmcnt(4)
    ds_read_b128 v[48:51], v4 offset:43008
    v_cvt_pk_bf16_f32 v180, v184, v185
    v_mfma_f32_16x16x32_bf16 v[240:243], v[144:147], v[56:59], v[240:243]
    s_cbranch_vccnz L_chk7
L_back7:
    v_exp_f32 v186, v186
    v_mfma_f32_16x16x32_bf16 v[248:251], v[148:151], v[56:59], v[248:251]
    ds_read_b128 v[52:55], v4 offset:47104
    ds_read_b128 v[56:59], v5 offset:44032
    v_mfma_f32_16x16x32_bf16 v[244:247], v[144:147], v[60:63], v[244:247]
    v_exp_f32 v187, v187
    v_mfma_f32_16x16x32_bf16 v[252:255], v[148:151], v[60:63], v[252:255]
    s_waitcnt lgkmcnt(5)
    ds_read_b128 v[60:63], v5 offset:48128
    v_cvt_pk_bf16_f32 v181, v186, v187
    v_mfma_f32_16x16x32_bf16 v[144:147], v[32:35], v[64:67], 0
    v_exp_f32 v188, v188
    v_mfma_f32_16x16x32_bf16 v[152:155], v[32:35], v[80:83], 0
    v_exp_f32 v189, v189
    v_mfma_f32_16x16x32_bf16 v[148:151], v[36:39], v[64:67], 0
    ds_read_b128 v[32:35], v6 offset:16384
    v_cvt_pk_bf16_f32 v182, v188, v189
    v_mfma_f32_16x16x32_bf16 v[156:159], v[36:39], v[80:83], 0
    s_waitcnt lgkmcnt(5)
    v_exp_f32 v190, v190
    v_mfma_f32_16x16x32_bf16 v[144:147], v[40:43], v[68:71], v[144:147]
    v_exp_f32 v191, v191
    v_mfma_f32_16x16x32_bf16 v[152:155], v[40:43], v[84:87], v[152:155]
    ds_read_b128 v[36:39], v7 offset:16640
    v_cvt_pk_bf16_f32 v183, v190, v191
    v_mfma_f32_16x16x32_bf16 v[148:151], v[44:47], v[68:71], v[148:151]
    v_exp_f32 v128, v128
    v_mfma_f32_16x16x32_bf16 v[156:159], v[44:47], v[84:87], v[156:159]
    ds_read_b128 v[40:43], v8 offset:16896
    ds_read_b128 v[44:47], v9 offset:17152
    v_smfmac_f32_16x16x64_bf16 v[16:19], v[12:15], v[176:183], v10
    s_waitcnt lgkmcnt(6)
    v_exp_f32 v129, v129
    v_mfma_f32_16x16x32_bf16 v[144:147], v[48:51], v[72:75], v[144:147]
    v_exp_f32 v130, v130
    v_mfma_f32_16x16x32_bf16 v[152:155], v[48:51], v[88:91], v[152:155]
    ds_read_b128 v[48:51], v6 offset:17408
    v_cvt_pk_bf16_f32 v128, v128, v129
    v_mfma_f32_16x16x32_bf16 v[148:151], v[52:55], v[72:75], v[148:151]
    v_exp_f32 v131, v131
    v_mfma_f32_16x16x32_bf16 v[156:159], v[52:55], v[88:91], v[156:159]
    s_waitcnt lgkmcnt(5)
    ds_read_b128 v[52:55], v7 offset:17664
    v_cvt_pk_bf16_f32 v129, v130, v131
    v_mfma_f32_16x16x32_bf16 v[144:147], v[56:59], v[76:79], v[144:147]
    v_exp_f32 v132, v132
    v_mfma_f32_16x16x32_bf16 v[152:155], v[56:59], v[92:95], v[152:155]
    v_exp_f32 v133, v133
    v_mfma_f32_16x16x32_bf16 v[148:151], v[60:63], v[76:79], v[148:151]
    ds_read_b128 v[56:59], v8 offset:17920
    v_cvt_pk_bf16_f32 v130, v132, v133
    v_mfma_f32_16x16x32_bf16 v[156:159], v[60:63], v[92:95], v[156:159]
    s_waitcnt lgkmcnt(5)
    v_exp_f32 v134, v134
    v_mfma_f32_16x16x32_bf16 v[192:195], v[160:163], v[32:35], v[192:195]
    v_exp_f32 v135, v135
    v_mfma_f32_16x16x32_bf16 v[200:203], v[164:167], v[32:35], v[200:203]
    ds_read_b128 v[60:63], v9 offset:18176
    v_cvt_pk_bf16_f32 v131, v134, v135
    v_mfma_f32_16x16x32_bf16 v[196:199], v[160:163], v[36:39], v[196:199]
    v_exp_f32 v136, v136
    v_mfma_f32_16x16x32_bf16 v[204:207], v[164:167], v[36:39], v[204:207]
    s_waitcnt lgkmcnt(4)
    ds_read_b128 v[32:35], v4 offset:49152
    ds_read_b128 v[36:39], v4 offset:53248
    v_mfma_f32_16x16x32_bf16 v[208:211], v[160:163], v[40:43], v[208:211]
    v_exp_f32 v137, v137
    v_mfma_f32_16x16x32_bf16 v[216:219], v[164:167], v[40:43], v[216:219]
    ds_read_b128 v[40:43], v5 offset:50176
    v_cvt_pk_bf16_f32 v132, v136, v137
    v_mfma_f32_16x16x32_bf16 v[212:215], v[160:163], v[44:47], v[212:215]
    v_exp_f32 v138, v138
    v_mfma_f32_16x16x32_bf16 v[220:223], v[164:167], v[44:47], v[220:223]
    s_waitcnt lgkmcnt(5)
    v_exp_f32 v139, v139
    v_mfma_f32_16x16x32_bf16 v[224:227], v[160:163], v[48:51], v[224:227]
    ds_read_b128 v[44:47], v5 offset:54272
    v_cvt_pk_bf16_f32 v133, v138, v139
    v_mfma_f32_16x16x32_bf16 v[232:235], v[164:167], v[48:51], v[232:235]
    v_exp_f32 v140, v140
    v_mfma_f32_16x16x32_bf16 v[228:231], v[160:163], v[52:55], v[228:231]
    v_exp_f32 v141, v141
    v_mfma_f32_16x16x32_bf16 v[236:239], v[164:167], v[52:55], v[236:239]
    s_waitcnt lgkmcnt(4)
    ds_read_b128 v[48:51], v4 offset:51200
    v_cvt_pk_bf16_f32 v134, v140, v141
    v_mfma_f32_16x16x32_bf16 v[240:243], v[160:163], v[56:59], v[240:243]
    v_exp_f32 v142, v142
    v_mfma_f32_16x16x32_bf16 v[248:251], v[164:167], v[56:59], v[248:251]
    ds_read_b128 v[52:55], v4 offset:55296
    ds_read_b128 v[56:59], v5 offset:52224
    v_mfma_f32_16x16x32_bf16 v[244:247], v[160:163], v[60:63], v[244:247]
    v_exp_f32 v143, v143
    v_mfma_f32_16x16x32_bf16 v[252:255], v[164:167], v[60:63], v[252:255]
    s_waitcnt lgkmcnt(5)
    ds_read_b128 v[60:63], v5 offset:56320
    v_cvt_pk_bf16_f32 v135, v142, v143
    v_mfma_f32_16x16x32_bf16 v[160:163], v[32:35], v[64:67], 0
    v_exp_f32 v144, v144
    v_mfma_f32_16x16x32_bf16 v[168:171], v[32:35], v[80:83], 0
    v_exp_f32 v145, v145
    v_smfmac_f32_16x16x64_bf16 v[16:19], v[12:15], v[128:135], v10
    ds_read_b128 v[32:35], v6 offset:24576
    v_cvt_pk_bf16_f32 v144, v144, v145
    v_mfma_f32_16x16x32_bf16 v[164:167], v[36:39], v[64:67], 0
    v_exp_f32 v146, v146
    v_mfma_f32_16x16x32_bf16 v[172:175], v[36:39], v[80:83], 0
    s_waitcnt lgkmcnt(5)
    v_exp_f32 v147, v147
    v_mfma_f32_16x16x32_bf16 v[160:163], v[40:43], v[68:71], v[160:163]
    ds_read_b128 v[36:39], v7 offset:24832
    v_cvt_pk_bf16_f32 v145, v146, v147
    v_mfma_f32_16x16x32_bf16 v[168:171], v[40:43], v[84:87], v[168:171]
    v_exp_f32 v148, v148
    v_mfma_f32_16x16x32_bf16 v[164:167], v[44:47], v[68:71], v[164:167]
    v_exp_f32 v149, v149
    v_mfma_f32_16x16x32_bf16 v[172:175], v[44:47], v[84:87], v[172:175]
    s_waitcnt lgkmcnt(4)
    ds_read_b128 v[40:43], v8 offset:25088
    v_cvt_pk_bf16_f32 v146, v148, v149
    v_mfma_f32_16x16x32_bf16 v[160:163], v[48:51], v[72:75], v[160:163]
    v_exp_f32 v150, v150
    v_mfma_f32_16x16x32_bf16 v[168:171], v[48:51], v[88:91], v[168:171]
    ds_read_b128 v[44:47], v9 offset:25344
    ds_read_b128 v[48:51], v6 offset:25600
    v_mfma_f32_16x16x32_bf16 v[164:167], v[52:55], v[72:75], v[164:167]
    v_exp_f32 v151, v151
    v_mfma_f32_16x16x32_bf16 v[172:175], v[52:55], v[88:91], v[172:175]
    s_waitcnt lgkmcnt(5)
    ds_read_b128 v[52:55], v7 offset:25856
    v_cvt_pk_bf16_f32 v147, v150, v151
    v_mfma_f32_16x16x32_bf16 v[160:163], v[56:59], v[76:79], v[160:163]
    v_exp_f32 v152, v152
    v_mfma_f32_16x16x32_bf16 v[168:171], v[56:59], v[92:95], v[168:171]
    v_exp_f32 v153, v153
    v_mfma_f32_16x16x32_bf16 v[164:167], v[60:63], v[76:79], v[164:167]
    ds_read_b128 v[56:59], v8 offset:26112
    v_cvt_pk_bf16_f32 v148, v152, v153
    v_mfma_f32_16x16x32_bf16 v[172:175], v[60:63], v[92:95], v[172:175]
    s_waitcnt lgkmcnt(5)
    v_exp_f32 v154, v154
    v_mfma_f32_16x16x32_bf16 v[192:195], v[176:179], v[32:35], v[192:195]
    v_exp_f32 v155, v155
    v_mfma_f32_16x16x32_bf16 v[200:203], v[180:183], v[32:35], v[200:203]
    ds_read_b128 v[60:63], v9 offset:26368
    v_cvt_pk_bf16_f32 v149, v154, v155
    v_mfma_f32_16x16x32_bf16 v[196:199], v[176:179], v[36:39], v[196:199]
    v_exp_f32 v156, v156
    v_mfma_f32_16x16x32_bf16 v[204:207], v[180:183], v[36:39], v[204:207]
    s_waitcnt lgkmcnt(4)
    ds_read_b128 v[32:35], v4 offset:57344
    ds_read_b128 v[36:39], v4 offset:61440
    v_mfma_f32_16x16x32_bf16 v[208:211], v[176:179], v[40:43], v[208:211]
    v_exp_f32 v157, v157
    v_mfma_f32_16x16x32_bf16 v[216:219], v[180:183], v[40:43], v[216:219]
    ds_read_b128 v[40:43], v5 offset:58368
    v_cvt_pk_bf16_f32 v150, v156, v157
    v_mfma_f32_16x16x32_bf16 v[212:215], v[176:179], v[44:47], v[212:215]
    v_exp_f32 v158, v158
    v_mfma_f32_16x16x32_bf16 v[220:223], v[180:183], v[44:47], v[220:223]
    s_waitcnt lgkmcnt(5)
    v_exp_f32 v159, v159
    v_mfma_f32_16x16x32_bf16 v[224:227], v[176:179], v[48:51], v[224:227]
    ds_read_b128 v[44:47], v5 offset:62464
    v_cvt_pk_bf16_f32 v151, v158, v159
    v_mfma_f32_16x16x32_bf16 v[232:235], v[180:183], v[48:51], v[232:235]
    v_exp_f32 v160, v160
    v_mfma_f32_16x16x32_bf16 v[228:231], v[176:179], v[52:55], v[228:231]
    v_exp_f32 v161, v161
    v_smfmac_f32_16x16x64_bf16 v[16:19], v[12:15], v[144:151], v10
    ds_read_b128 v[48:51], v4 offset:59392
    v_cvt_pk_bf16_f32 v160, v160, v161
    v_mfma_f32_16x16x32_bf16 v[236:239], v[180:183], v[52:55], v[236:239]
    s_waitcnt lgkmcnt(5)
    v_exp_f32 v162, v162
    v_mfma_f32_16x16x32_bf16 v[240:243], v[176:179], v[56:59], v[240:243]
    v_exp_f32 v163, v163
    v_mfma_f32_16x16x32_bf16 v[248:251], v[180:183], v[56:59], v[248:251]
    ds_read_b128 v[52:55], v4 offset:63488
    v_cvt_pk_bf16_f32 v161, v162, v163
    v_mfma_f32_16x16x32_bf16 v[244:247], v[176:179], v[60:63], v[244:247]
    v_exp_f32 v164, v164
    v_mfma_f32_16x16x32_bf16 v[252:255], v[180:183], v[60:63], v[252:255]
    s_waitcnt lgkmcnt(4)
    ds_read_b128 v[56:59], v5 offset:60416
    ds_read_b128 v[60:63], v5 offset:64512
    v_mfma_f32_16x16x32_bf16 v[176:179], v[32:35], v[64:67], 0
    v_exp_f32 v165, v165
    v_mfma_f32_16x16x32_bf16 v[184:187], v[32:35], v[80:83], 0
    ds_read_b128 v[32:35], v6 offset:32768
    v_cvt_pk_bf16_f32 v162, v164, v165
    v_mfma_f32_16x16x32_bf16 v[180:183], v[36:39], v[64:67], 0
    v_exp_f32 v166, v166
    v_mfma_f32_16x16x32_bf16 v[188:191], v[36:39], v[80:83], 0
    s_waitcnt lgkmcnt(5)
    v_exp_f32 v167, v167
    v_mfma_f32_16x16x32_bf16 v[176:179], v[40:43], v[68:71], v[176:179]
    s_setprio 3
    ds_read_b128 v[36:39], v7 offset:33024
    v_cvt_pk_bf16_f32 v163, v166, v167
    v_mfma_f32_16x16x32_bf16 v[184:187], v[40:43], v[84:87], v[184:187]
    v_exp_f32 v168, v168
    v_mfma_f32_16x16x32_bf16 v[180:183], v[44:47], v[68:71], v[180:183]
    v_exp_f32 v169, v169
    v_mfma_f32_16x16x32_bf16 v[188:191], v[44:47], v[84:87], v[188:191]
    s_waitcnt lgkmcnt(4)
    ds_read_b128 v[40:43], v8 offset:33280
    v_cvt_pk_bf16_f32 v164, v168, v169
    v_mfma_f32_16x16x32_bf16 v[176:179], v[48:51], v[72:75], v[176:179]
    v_exp_f32 v170, v170
    v_mfma_f32_16x16x32_bf16 v[184:187], v[48:51], v[88:91], v[184:187]
    ds_read_b128 v[44:47], v9 offset:33536
    ds_read_b128 v[48:51], v6 offset:33792
    v_mfma_f32_16x16x32_bf16 v[180:183], v[52:55], v[72:75], v[180:183]
    v_exp_f32 v171, v171
    v_mfma_f32_16x16x32_bf16 v[188:191], v[52:55], v[88:91], v[188:191]
    s_waitcnt lgkmcnt(5)
    ds_read_b128 v[52:55], v7 offset:34048
    v_cvt_pk_bf16_f32 v165, v170, v171
    v_mfma_f32_16x16x32_bf16 v[176:179], v[56:59], v[76:79], v[176:179]
    v_exp_f32 v172, v172
    v_mfma_f32_16x16x32_bf16 v[184:187], v[56:59], v[92:95], v[184:187]
    v_exp_f32 v173, v173
    v_mfma_f32_16x16x32_bf16 v[180:183], v[60:63], v[76:79], v[180:183]
    ds_read_b128 v[56:59], v8 offset:34304
    v_cvt_pk_bf16_f32 v166, v172, v173
    v_mfma_f32_16x16x32_bf16 v[188:191], v[60:63], v[92:95], v[188:191]
    s_waitcnt lgkmcnt(5)
    v_exp_f32 v174, v174
    v_mfma_f32_16x16x32_bf16 v[192:195], v[128:131], v[32:35], v[192:195]
    v_exp_f32 v175, v175
    v_mfma_f32_16x16x32_bf16 v[200:203], v[132:135], v[32:35], v[200:203]
    ds_read_b128 v[60:63], v9 offset:34560
    v_cvt_pk_bf16_f32 v167, v174, v175
    v_mfma_f32_16x16x32_bf16 v[196:199], v[128:131], v[36:39], v[196:199]
    buffer_load_dwordx4 v[64:67], v2, s[48:51], s44 offen offset:0
    buffer_load_dwordx4 v[68:71], v2, s[48:51], s44 offen offset:64
    buffer_load_dwordx4 v[72:75], v2, s[48:51], s44 offen offset:128
    buffer_load_dwordx4 v[76:79], v2, s[48:51], s44 offen offset:192
    buffer_load_dwordx4 v[80:83], v2, s[48:51], s59 offen offset:0
    buffer_load_dwordx4 v[84:87], v2, s[48:51], s59 offen offset:64
    buffer_load_dwordx4 v[88:91], v2, s[48:51], s59 offen offset:128
    buffer_load_dwordx4 v[92:95], v2, s[48:51], s59 offen offset:192
    v_exp_f32 v176, v176
    v_mfma_f32_16x16x32_bf16 v[204:207], v[132:135], v[36:39], v[204:207]
    ds_read_b128 v[32:35], v6 offset:40960
    ds_read_b128 v[36:39], v7 offset:41216
    v_smfmac_f32_16x16x64_bf16 v[16:19], v[12:15], v[160:167], v10
    s_waitcnt lgkmcnt(6)
    v_exp_f32 v177, v177
    v_mfma_f32_16x16x32_bf16 v[208:211], v[128:131], v[40:43], v[208:211]
    v_exp_f32 v178, v178
    v_mfma_f32_16x16x32_bf16 v[216:219], v[132:135], v[40:43], v[216:219]
    ds_read_b128 v[40:43], v8 offset:41472
    v_cvt_pk_bf16_f32 v176, v176, v177
    v_mfma_f32_16x16x32_bf16 v[212:215], v[128:131], v[44:47], v[212:215]
    v_exp_f32 v179, v179
    v_mfma_f32_16x16x32_bf16 v[220:223], v[132:135], v[44:47], v[220:223]
    s_waitcnt lgkmcnt(5)
    ds_read_b128 v[44:47], v9 offset:41728
    v_cvt_pk_bf16_f32 v177, v178, v179
    v_mfma_f32_16x16x32_bf16 v[224:227], v[128:131], v[48:51], v[224:227]
    v_exp_f32 v180, v180
    v_mfma_f32_16x16x32_bf16 v[232:235], v[132:135], v[48:51], v[232:235]
    v_exp_f32 v181, v181
    v_mfma_f32_16x16x32_bf16 v[228:231], v[128:131], v[52:55], v[228:231]
    ds_read_b128 v[48:51], v6 offset:41984
    v_cvt_pk_bf16_f32 v178, v180, v181
    v_mfma_f32_16x16x32_bf16 v[236:239], v[132:135], v[52:55], v[236:239]
    s_waitcnt lgkmcnt(5)
    v_exp_f32 v182, v182
    v_mfma_f32_16x16x32_bf16 v[240:243], v[128:131], v[56:59], v[240:243]
    v_exp_f32 v183, v183
    v_mfma_f32_16x16x32_bf16 v[248:251], v[132:135], v[56:59], v[248:251]
    ds_read_b128 v[52:55], v7 offset:42240
    v_cvt_pk_bf16_f32 v179, v182, v183
    v_mfma_f32_16x16x32_bf16 v[244:247], v[128:131], v[60:63], v[244:247]
    v_exp_f32 v184, v184
    v_mfma_f32_16x16x32_bf16 v[252:255], v[132:135], v[60:63], v[252:255]
    s_waitcnt lgkmcnt(4)
    ds_read_b128 v[56:59], v8 offset:42496
    ds_read_b128 v[60:63], v9 offset:42752
    v_mfma_f32_16x16x32_bf16 v[192:195], v[144:147], v[32:35], v[192:195]
    v_exp_f32 v185, v185
    v_mfma_f32_16x16x32_bf16 v[200:203], v[148:151], v[32:35], v[200:203]
    ds_read_b128 v[32:35], v6 offset:49152
    v_cvt_pk_bf16_f32 v180, v184, v185
    v_mfma_f32_16x16x32_bf16 v[196:199], v[144:147], v[36:39], v[196:199]
    v_exp_f32 v186, v186
    v_mfma_f32_16x16x32_bf16 v[204:207], v[148:151], v[36:39], v[204:207]
    s_waitcnt lgkmcnt(5)
    v_exp_f32 v187, v187
    v_mfma_f32_16x16x32_bf16 v[208:211], v[144:147], v[40:43], v[208:211]
    ds_read_b128 v[36:39], v7 offset:49408
    v_cvt_pk_bf16_f32 v181, v186, v187
    v_mfma_f32_16x16x32_bf16 v[216:219], v[148:151], v[40:43], v[216:219]
    v_exp_f32 v188, v188
    v_mfma_f32_16x16x32_bf16 v[212:215], v[144:147], v[44:47], v[212:215]
    v_exp_f32 v189, v189
    v_mfma_f32_16x16x32_bf16 v[220:223], v[148:151], v[44:47], v[220:223]
    s_waitcnt lgkmcnt(4)
    ds_read_b128 v[40:43], v6 offset:57344
    v_cvt_pk_bf16_f32 v182, v188, v189
    v_mfma_f32_16x16x32_bf16 v[224:227], v[144:147], v[48:51], v[224:227]
    v_exp_f32 v190, v190
    v_mfma_f32_16x16x32_bf16 v[232:235], v[148:151], v[48:51], v[232:235]
    ds_read_b128 v[44:47], v7 offset:57600
    ds_read_b128 v[48:51], v8 offset:49664
    v_mfma_f32_16x16x32_bf16 v[228:231], v[144:147], v[52:55], v[228:231]
    v_exp_f32 v191, v191
    v_mfma_f32_16x16x32_bf16 v[236:239], v[148:151], v[52:55], v[236:239]
    s_waitcnt lgkmcnt(5)
    ds_read_b128 v[52:55], v9 offset:49920
    v_cvt_pk_bf16_f32 v183, v190, v191
    v_mfma_f32_16x16x32_bf16 v[240:243], v[144:147], v[56:59], v[240:243]
    v_mfma_f32_16x16x32_bf16 v[248:251], v[148:151], v[56:59], v[248:251]
    ds_read_b128 v[56:59], v8 offset:57856
    v_smfmac_f32_16x16x64_bf16 v[16:19], v[12:15], v[176:183], v10
    v_mfma_f32_16x16x32_bf16 v[244:247], v[144:147], v[60:63], v[244:247]
    v_mfma_f32_16x16x32_bf16 v[252:255], v[148:151], v[60:63], v[252:255]
    s_waitcnt lgkmcnt(5)
    ds_read_b128 v[60:63], v9 offset:58112
    v_mfma_f32_16x16x32_bf16 v[192:195], v[160:163], v[32:35], v[192:195]
    v_mfma_f32_16x16x32_bf16 v[200:203], v[164:167], v[32:35], v[200:203]
    ds_read_b128 v[32:35], v6 offset:50176
    v_mfma_f32_16x16x32_bf16 v[196:199], v[160:163], v[36:39], v[196:199]
    v_mfma_f32_16x16x32_bf16 v[204:207], v[164:167], v[36:39], v[204:207]
    s_waitcnt lgkmcnt(5)
    ds_read_b128 v[36:39], v7 offset:50432
    v_mfma_f32_16x16x32_bf16 v[192:195], v[176:179], v[40:43], v[192:195]
    v_add_f32 v20, v16, v17
    v_add_f32 v21, v18, v19
    v_mfma_f32_16x16x32_bf16 v[200:203], v[180:183], v[40:43], v[200:203]
    v_rcp_f32 v20, v20
    v_mfma_f32_16x16x32_bf16 v[196:199], v[176:179], v[44:47], v[196:199]
    v_rcp_f32 v21, v21
    v_mfma_f32_16x16x32_bf16 v[204:207], v[180:183], v[44:47], v[204:207]
    s_waitcnt lgkmcnt(4)
    ds_read_b128 v[40:43], v6 offset:58368
    v_mov_b32_dpp v20, v20 row_ror:12 row_mask:0x2 bank_mask:0xf
    v_mfma_f32_16x16x32_bf16 v[208:211], v[160:163], v[48:51], v[208:211]
    ds_read_b128 v[44:47], v7 offset:58624
    v_mov_b32_dpp v21, v21 row_ror:12 row_mask:0x2 bank_mask:0xf
    v_mfma_f32_16x16x32_bf16 v[216:219], v[164:167], v[48:51], v[216:219]
    ds_read_b128 v[48:51], v8 offset:50688
    v_mov_b32_dpp v20, v20 row_ror:8 row_mask:0x4 bank_mask:0xf
    v_mfma_f32_16x16x32_bf16 v[212:215], v[160:163], v[52:55], v[212:215]
    v_mov_b32_dpp v21, v21 row_ror:8 row_mask:0x4 bank_mask:0xf
    v_mfma_f32_16x16x32_bf16 v[220:223], v[164:167], v[52:55], v[220:223]
    s_waitcnt lgkmcnt(5)
    ds_read_b128 v[52:55], v9 offset:50944
    v_mov_b32_dpp v20, v20 row_ror:4 row_mask:0x8 bank_mask:0xf
    v_mfma_f32_16x16x32_bf16 v[208:211], v[176:179], v[56:59], v[208:211]
    v_mov_b32_dpp v21, v21 row_ror:4 row_mask:0x8 bank_mask:0xf
    v_subrev_u32 v24, s100, v20
    v_mfma_f32_16x16x32_bf16 v[216:219], v[180:183], v[56:59], v[216:219]
    ds_read_b128 v[56:59], v8 offset:58880
    v_subrev_u32 v25, s100, v21
    v_mfma_f32_16x16x32_bf16 v[212:215], v[176:179], v[60:63], v[212:215]
    v_max_u32 v24, v24, v25
    v_mul_f32_dpp v192, v20, v192 row_newbcast:0 row_mask:0xf bank_mask:0xf
    v_mfma_f32_16x16x32_bf16 v[220:223], v[180:183], v[60:63], v[220:223]
    s_waitcnt lgkmcnt(5)
    ds_read_b128 v[60:63], v9 offset:59136
    v_cmp_le_u32 vcc, s29, v24
    v_mfma_f32_16x16x32_bf16 v[224:227], v[160:163], v[32:35], v[224:227]
    v_mul_f32_dpp v196, v20, v196 row_newbcast:0 row_mask:0xf bank_mask:0xf
    v_mul_f32_dpp v193, v20, v193 row_newbcast:1 row_mask:0xf bank_mask:0xf
    v_mfma_f32_16x16x32_bf16 v[232:235], v[164:167], v[32:35], v[232:235]
    v_mul_f32_dpp v197, v20, v197 row_newbcast:1 row_mask:0xf bank_mask:0xf
    v_cvt_pk_bf16_f32 v128, v192, v196
    v_mfma_f32_16x16x32_bf16 v[228:231], v[160:163], v[36:39], v[228:231]
    v_mul_f32_dpp v194, v20, v194 row_newbcast:2 row_mask:0xf bank_mask:0xf
    v_mul_f32_dpp v198, v20, v198 row_newbcast:2 row_mask:0xf bank_mask:0xf
    v_mfma_f32_16x16x32_bf16 v[236:239], v[164:167], v[36:39], v[236:239]
    s_waitcnt lgkmcnt(4)
    v_cvt_pk_bf16_f32 v132, v193, v197
    v_mul_f32_dpp v195, v20, v195 row_newbcast:3 row_mask:0xf bank_mask:0xf
    v_mfma_f32_16x16x32_bf16 v[224:227], v[176:179], v[40:43], v[224:227]
    v_mul_f32_dpp v199, v20, v199 row_newbcast:3 row_mask:0xf bank_mask:0xf
    v_cvt_pk_bf16_f32 v136, v194, v198
    v_mfma_f32_16x16x32_bf16 v[232:235], v[180:183], v[40:43], v[232:235]
    v_mul_f32_dpp v200, v21, v200 row_newbcast:0 row_mask:0xf bank_mask:0xf
    v_mul_f32_dpp v204, v21, v204 row_newbcast:0 row_mask:0xf bank_mask:0xf
    v_mfma_f32_16x16x32_bf16 v[228:231], v[176:179], v[44:47], v[228:231]
    v_cvt_pk_bf16_f32 v140, v195, v199
    v_mul_f32_dpp v201, v21, v201 row_newbcast:1 row_mask:0xf bank_mask:0xf
    v_mfma_f32_16x16x32_bf16 v[236:239], v[180:183], v[44:47], v[236:239]
    s_waitcnt lgkmcnt(2)
    v_mul_f32_dpp v205, v21, v205 row_newbcast:1 row_mask:0xf bank_mask:0xf
    v_cvt_pk_bf16_f32 v144, v200, v204
    v_mfma_f32_16x16x32_bf16 v[240:243], v[160:163], v[48:51], v[240:243]
    v_mul_f32_dpp v202, v21, v202 row_newbcast:2 row_mask:0xf bank_mask:0xf
    v_mul_f32_dpp v206, v21, v206 row_newbcast:2 row_mask:0xf bank_mask:0xf
    v_mfma_f32_16x16x32_bf16 v[248:251], v[164:167], v[48:51], v[248:251]
    v_cvt_pk_bf16_f32 v148, v201, v205
    v_mul_f32_dpp v203, v21, v203 row_newbcast:3 row_mask:0xf bank_mask:0xf
    v_mfma_f32_16x16x32_bf16 v[244:247], v[160:163], v[52:55], v[244:247]
    v_mul_f32_dpp v207, v21, v207 row_newbcast:3 row_mask:0xf bank_mask:0xf
    v_cvt_pk_bf16_f32 v152, v202, v206
    v_mfma_f32_16x16x32_bf16 v[252:255], v[164:167], v[52:55], v[252:255]
    s_waitcnt lgkmcnt(0)
    v_mul_f32_dpp v208, v20, v208 row_newbcast:0 row_mask:0xf bank_mask:0xf
    v_mul_f32_dpp v212, v20, v212 row_newbcast:0 row_mask:0xf bank_mask:0xf
    v_mfma_f32_16x16x32_bf16 v[240:243], v[176:179], v[56:59], v[240:243]
    v_cvt_pk_bf16_f32 v156, v203, v207
    v_mul_f32_dpp v209, v20, v209 row_newbcast:1 row_mask:0xf bank_mask:0xf
    v_mfma_f32_16x16x32_bf16 v[248:251], v[180:183], v[56:59], v[248:251]
    v_mul_f32_dpp v213, v20, v213 row_newbcast:1 row_mask:0xf bank_mask:0xf
    v_cvt_pk_bf16_f32 v129, v208, v212
    v_mfma_f32_16x16x32_bf16 v[244:247], v[176:179], v[60:63], v[244:247]
    v_mul_f32_dpp v210, v20, v210 row_newbcast:2 row_mask:0xf bank_mask:0xf
    v_mul_f32_dpp v214, v20, v214 row_newbcast:2 row_mask:0xf bank_mask:0xf
    v_mfma_f32_16x16x32_bf16 v[252:255], v[180:183], v[60:63], v[252:255]
    s_setprio 0
    v_cvt_pk_bf16_f32 v133, v209, v213
    v_mul_f32_dpp v211, v20, v211 row_newbcast:3 row_mask:0xf bank_mask:0xf
    v_mul_f32_dpp v215, v20, v215 row_newbcast:3 row_mask:0xf bank_mask:0xf
    v_cvt_pk_bf16_f32 v137, v210, v214
    v_mul_f32_dpp v216, v21, v216 row_newbcast:0 row_mask:0xf bank_mask:0xf
    v_mul_f32_dpp v220, v21, v220 row_newbcast:0 row_mask:0xf bank_mask:0xf
    v_cvt_pk_bf16_f32 v141, v211, v215
    v_mul_f32_dpp v217, v21, v217 row_newbcast:1 row_mask:0xf bank_mask:0xf
    v_mul_f32_dpp v221, v21, v221 row_newbcast:1 row_mask:0xf bank_mask:0xf
    v_cvt_pk_bf16_f32 v145, v216, v220
    v_mul_f32_dpp v218, v21, v218 row_newbcast:2 row_mask:0xf bank_mask:0xf
    v_mul_f32_dpp v222, v21, v222 row_newbcast:2 row_mask:0xf bank_mask:0xf
    v_cvt_pk_bf16_f32 v149, v217, v221
    v_mul_f32_dpp v219, v21, v219 row_newbcast:3 row_mask:0xf bank_mask:0xf
    v_mul_f32_dpp v223, v21, v223 row_newbcast:3 row_mask:0xf bank_mask:0xf
    v_cvt_pk_bf16_f32 v153, v218, v222
    v_mul_f32_dpp v224, v20, v224 row_newbcast:0 row_mask:0xf bank_mask:0xf
    v_mul_f32_dpp v228, v20, v228 row_newbcast:0 row_mask:0xf bank_mask:0xf
    v_cvt_pk_bf16_f32 v157, v219, v223
    v_mul_f32_dpp v240, v20, v240 row_newbcast:0 row_mask:0xf bank_mask:0xf
    v_mul_f32_dpp v244, v20, v244 row_newbcast:0 row_mask:0xf bank_mask:0xf
    v_cvt_pk_bf16_f32 v130, v224, v228
    v_mul_f32_dpp v225, v20, v225 row_newbcast:1 row_mask:0xf bank_mask:0xf
    v_mul_f32_dpp v229, v20, v229 row_newbcast:1 row_mask:0xf bank_mask:0xf
    v_cvt_pk_bf16_f32 v131, v240, v244
    v_mul_f32_dpp v241, v20, v241 row_newbcast:1 row_mask:0xf bank_mask:0xf
    v_mul_f32_dpp v245, v20, v245 row_newbcast:1 row_mask:0xf bank_mask:0xf
    v_cvt_pk_bf16_f32 v134, v225, v229
    v_mul_f32_dpp v226, v20, v226 row_newbcast:2 row_mask:0xf bank_mask:0xf
    v_mul_f32_dpp v230, v20, v230 row_newbcast:2 row_mask:0xf bank_mask:0xf
    s_cbranch_vccnz L_fb
    buffer_store_dwordx4 v[128:131], v3, s[20:23], s30 offen offset:0 sc1
    v_cvt_pk_bf16_f32 v135, v241, v245
    v_mul_f32_dpp v242, v20, v242 row_newbcast:2 row_mask:0xf bank_mask:0xf
    v_mul_f32_dpp v246, v20, v246 row_newbcast:2 row_mask:0xf bank_mask:0xf
    v_cvt_pk_bf16_f32 v138, v226, v230
    v_mul_f32_dpp v227, v20, v227 row_newbcast:3 row_mask:0xf bank_mask:0xf
    v_mul_f32_dpp v231, v20, v231 row_newbcast:3 row_mask:0xf bank_mask:0xf
    buffer_store_dwordx4 v[132:135], v3, s[20:23], s30 offen offset:1024 sc1
    v_cvt_pk_bf16_f32 v139, v242, v246
    v_mul_f32_dpp v243, v20, v243 row_newbcast:3 row_mask:0xf bank_mask:0xf
    v_mul_f32_dpp v247, v20, v247 row_newbcast:3 row_mask:0xf bank_mask:0xf
    v_cvt_pk_bf16_f32 v142, v227, v231
    v_mul_f32_dpp v232, v21, v232 row_newbcast:0 row_mask:0xf bank_mask:0xf
    v_mul_f32_dpp v236, v21, v236 row_newbcast:0 row_mask:0xf bank_mask:0xf
    buffer_store_dwordx4 v[136:139], v3, s[20:23], s30 offen offset:2048 sc1
    v_cvt_pk_bf16_f32 v143, v243, v247
    v_mul_f32_dpp v248, v21, v248 row_newbcast:0 row_mask:0xf bank_mask:0xf
    v_mul_f32_dpp v252, v21, v252 row_newbcast:0 row_mask:0xf bank_mask:0xf
    v_cvt_pk_bf16_f32 v146, v232, v236
    v_mul_f32_dpp v233, v21, v233 row_newbcast:1 row_mask:0xf bank_mask:0xf
    v_mul_f32_dpp v237, v21, v237 row_newbcast:1 row_mask:0xf bank_mask:0xf
    buffer_store_dwordx4 v[140:143], v3, s[20:23], s30 offen offset:3072 sc1
    v_cvt_pk_bf16_f32 v147, v248, v252
    v_mul_f32_dpp v249, v21, v249 row_newbcast:1 row_mask:0xf bank_mask:0xf
    v_mul_f32_dpp v253, v21, v253 row_newbcast:1 row_mask:0xf bank_mask:0xf
    v_cvt_pk_bf16_f32 v150, v233, v237
    v_mul_f32_dpp v234, v21, v234 row_newbcast:2 row_mask:0xf bank_mask:0xf
    v_mul_f32_dpp v238, v21, v238 row_newbcast:2 row_mask:0xf bank_mask:0xf
    buffer_store_dwordx4 v[144:147], v3, s[20:23], s31 offen offset:0 sc1
    v_cvt_pk_bf16_f32 v151, v249, v253
    v_mul_f32_dpp v250, v21, v250 row_newbcast:2 row_mask:0xf bank_mask:0xf
    v_mul_f32_dpp v254, v21, v254 row_newbcast:2 row_mask:0xf bank_mask:0xf
    v_cvt_pk_bf16_f32 v154, v234, v238
    v_mul_f32_dpp v235, v21, v235 row_newbcast:3 row_mask:0xf bank_mask:0xf
    v_mul_f32_dpp v239, v21, v239 row_newbcast:3 row_mask:0xf bank_mask:0xf
    buffer_store_dwordx4 v[148:151], v3, s[20:23], s31 offen offset:1024 sc1
    v_cvt_pk_bf16_f32 v155, v250, v254
    v_mul_f32_dpp v251, v21, v251 row_newbcast:3 row_mask:0xf bank_mask:0xf
    v_mul_f32_dpp v255, v21, v255 row_newbcast:3 row_mask:0xf bank_mask:0xf
    v_cvt_pk_bf16_f32 v158, v235, v239
    v_cvt_pk_bf16_f32 v159, v251, v255
    buffer_store_dwordx4 v[152:155], v3, s[20:23], s31 offen offset:2048 sc1
    buffer_store_dwordx4 v[156:159], v3, s[20:23], s31 offen offset:3072 sc1
    s_cmp_eq_u32 s45, 1
    s_cbranch_scc1 L_done
L_tend:
    s_mov_b32 s45, 1
    s_mov_b32 s50, 0
    s_mov_b64 vcc, 0
    s_mov_b32 s30, s44
    s_add_u32 s31, s44, 4096
    ds_read_b128 v[32:35], v4 offset:0
    ds_read_b128 v[36:39], v4 offset:4096
    ds_read_b128 v[40:43], v5 offset:1024
    ds_read_b128 v[44:47], v5 offset:5120
    ds_read_b128 v[48:51], v4 offset:2048
    ds_read_b128 v[52:55], v4 offset:6144
    ds_read_b128 v[56:59], v5 offset:3072
    ds_read_b128 v[60:63], v5 offset:7168
    v_mov_b64 v[16:17], 0
    v_mov_b64 v[18:19], 0
    s_waitcnt vmcnt(8)
    s_setprio 1
    s_cmp_eq_u32 s45, 1
    s_branch L_bodyB
L_chk0:
    s_and_b32 s27, s46, s92
    s_cbranch_scc0 L_back0
L_slow0:
    ds_read_b32 v29, v31
    s_waitcnt lgkmcnt(0)
    v_readfirstlane_b32 s46, v29
    s_and_b32 s27, s46, s92
    s_cbranch_scc1 L_slow0
    s_branch L_back0
L_chk1:
    s_and_b32 s27, s46, s93
    s_cbranch_scc0 L_back1
L_slow1:
    ds_read_b32 v29, v31
    s_waitcnt lgkmcnt(0)
    v_readfirstlane_b32 s46, v29
    s_and_b32 s27, s46, s93
    s_cbranch_scc1 L_slow1
    s_branch L_back1
L_chk2:
    s_and_b32 s27, s46, s94
    s_cbranch_scc0 L_back2
L_slow2:
    ds_read_b32 v29, v31
    s_waitcnt lgkmcnt(0)
    v_readfirstlane_b32 s46, v29
    s_and_b32 s27, s46, s94
    s_cbranch_scc1 L_slow2
    s_branch L_back2
L_chk3:
    s_and_b32 s27, s46, s95
    s_cbranch_scc0 L_back3
L_slow3:
    ds_read_b32 v29, v31
    s_waitcnt lgkmcnt(0)
    v_readfirstlane_b32 s46, v29
    s_and_b32 s27, s46, s95
    s_cbranch_scc1 L_slow3
    s_branch L_back3
L_chk4:
    s_and_b32 s27, s46, s96
    s_cbranch_scc0 L_back4
L_slow4:
    ds_read_b32 v29, v31
    s_waitcnt lgkmcnt(0)
    v_readfirstlane_b32 s46, v29
    s_and_b32 s27, s46, s96
    s_cbranch_scc1 L_slow4
    s_branch L_back4
L_chk5:
    s_and_b32 s27, s46, s97
    s_cbranch_scc0 L_back5
L_slow5:
    ds_read_b32 v29, v31
    s_waitcnt lgkmcnt(0)
    v_readfirstlane_b32 s46, v29
    s_and_b32 s27, s46, s97
    s_cbranch_scc1 L_slow5
    s_branch L_back5
L_chk6:
    s_and_b32 s27, s46, s98
    s_cbranch_scc0 L_back6
L_slow6:
    ds_read_b32 v29, v31
    s_waitcnt lgkmcnt(0)
    v_readfirstlane_b32 s46, v29
    s_and_b32 s27, s46, s98
    s_cbranch_scc1 L_slow6
    s_branch L_back6
L_chk7:
    s_and_b32 s27, s46, s99
    s_cbranch_scc0 L_back7
L_slow7:
    ds_read_b32 v29, v31
    s_waitcnt lgkmcnt(0)
    v_readfirstlane_b32 s46, v29
    s_and_b32 s27, s46, s99
    s_cbranch_scc1 L_slow7
    s_branch L_back7
L_done:
L_end:
    s_endpgm
L_hot_end:
L_fb:
    s_waitcnt vmcnt(0)
    buffer_load_dwordx4 v[64:67], v2, s[8:11], s30 offen offset:0
    buffer_load_dwordx4 v[68:71], v2, s[8:11], s30 offen offset:64
    buffer_load_dwordx4 v[72:75], v2, s[8:11], s30 offen offset:128
    buffer_load_dwordx4 v[76:79], v2, s[8:11], s30 offen offset:192
    buffer_load_dwordx4 v[80:83], v2, s[8:11], s31 offen offset:0
    buffer_load_dwordx4 v[84:87], v2, s[8:11], s31 offen offset:64
    buffer_load_dwordx4 v[88:91], v2, s[8:11], s31 offen offset:128
    buffer_load_dwordx4 v[92:95], v2, s[8:11], s31 offen offset:192
    s_waitcnt lgkmcnt(0)
    s_nop 15
    ds_read_b128 v[32:35], v4 offset:0
    ds_read_b128 v[36:39], v4 offset:4096
    ds_read_b128 v[40:43], v5 offset:1024
    ds_read_b128 v[44:47], v5 offset:5120
    ds_read_b128 v[48:51], v4 offset:2048
    ds_read_b128 v[52:55], v4 offset:6144
    ds_read_b128 v[56:59], v5 offset:3072
    s_waitcnt vmcnt(0)
    s_waitcnt lgkmcnt(6)
    v_mfma_f32_16x16x32_bf16 v[128:131], v[32:35], v[64:67], 0
    v_mfma_f32_16x16x32_bf16 v[136:139], v[32:35], v[80:83], 0
    ds_read_b128 v[60:63], v5 offset:7168
    s_waitcnt lgkmcnt(6)
    v_mfma_f32_16x16x32_bf16 v[132:135], v[36:39], v[64:67], 0
    v_mfma_f32_16x16x32_bf16 v[140:143], v[36:39], v[80:83], 0
    ds_read_b128 v[32:35], v4 offset:8192
    s_waitcnt lgkmcnt(6)
    v_mfma_f32_16x16x32_bf16 v[128:131], v[40:43], v[68:71], v[128:131]
    v_mfma_f32_16x16x32_bf16 v[136:139], v[40:43], v[84:87], v[136:139]
    ds_read_b128 v[36:39], v4 offset:12288
    s_waitcnt lgkmcnt(6)
    v_mfma_f32_16x16x32_bf16 v[132:135], v[44:47], v[68:71], v[132:135]
    v_mfma_f32_16x16x32_bf16 v[140:143], v[44:47], v[84:87], v[140:143]
    ds_read_b128 v[40:43], v5 offset:9216
    s_waitcnt lgkmcnt(6)
    v_mfma_f32_16x16x32_bf16 v[128:131], v[48:51], v[72:75], v[128:131]
    v_mfma_f32_16x16x32_bf16 v[136:139], v[48:51], v[88:91], v[136:139]
    ds_read_b128 v[44:47], v5 offset:13312
    s_waitcnt lgkmcnt(6)
    v_mfma_f32_16x16x32_bf16 v[132:135], v[52:55], v[72:75], v[132:135]
    v_mfma_f32_16x16x32_bf16 v[140:143], v[52:55], v[88:91], v[140:143]
    ds_read_b128 v[48:51], v4 offset:10240
    s_waitcnt lgkmcnt(6)
    v_mfma_f32_16x16x32_bf16 v[128:131], v[56:59], v[76:79], v[128:131]
    v_mfma_f32_16x16x32_bf16 v[136:139], v[56:59], v[92:95], v[136:139]
    ds_read_b128 v[52:55], v4 offset:14336
    s_waitcnt lgkmcnt(6)
    v_mfma_f32_16x16x32_bf16 v[132:135], v[60:63], v[76:79], v[132:135]
    v_mfma_f32_16x16x32_bf16 v[140:143], v[60:63], v[92:95], v[140:143]
    ds_read_b128 v[56:59], v5 offset:11264
    s_waitcnt lgkmcnt(6)
    v_mfma_f32_16x16x32_bf16 v[144:147], v[32:35], v[64:67], 0
    v_mfma_f32_16x16x32_bf16 v[152:155], v[32:35], v[80:83], 0
    ds_read_b128 v[60:63], v5 offset:15360
    s_waitcnt lgkmcnt(6)
    v_mfma_f32_16x16x32_bf16 v[148:151], v[36:39], v[64:67], 0
    v_mfma_f32_16x16x32_bf16 v[156:159], v[36:39], v[80:83], 0
    ds_read_b128 v[32:35], v4 offset:16384
    s_waitcnt lgkmcnt(6)
    v_mfma_f32_16x16x32_bf16 v[144:147], v[40:43], v[68:71], v[144:147]
    v_mfma_f32_16x16x32_bf16 v[152:155], v[40:43], v[84:87], v[152:155]
    ds_read_b128 v[36:39], v4 offset:20480
    s_waitcnt lgkmcnt(6)
    v_mfma_f32_16x16x32_bf16 v[148:151], v[44:47], v[68:71], v[148:151]
    v_mfma_f32_16x16x32_bf16 v[156:159], v[44:47], v[84:87], v[156:159]
    ds_read_b128 v[40:43], v5 offset:17408
    s_waitcnt lgkmcnt(6)
    v_mfma_f32_16x16x32_bf16 v[144:147], v[48:51], v[72:75], v[144:147]
    v_mfma_f32_16x16x32_bf16 v[152:155], v[48:51], v[88:91], v[152:155]
    ds_read_b128 v[44:47], v5 offset:21504
    s_waitcnt lgkmcnt(6)
    v_mfma_f32_16x16x32_bf16 v[148:151], v[52:55], v[72:75], v[148:151]
    v_mfma_f32_16x16x32_bf16 v[156:159], v[52:55], v[88:91], v[156:159]
    ds_read_b128 v[48:51], v4 offset:18432
    s_waitcnt lgkmcnt(6)
    v_mfma_f32_16x16x32_bf16 v[144:147], v[56:59], v[76:79], v[144:147]
    v_mfma_f32_16x16x32_bf16 v[152:155], v[56:59], v[92:95], v[152:155]
    ds_read_b128 v[52:55], v4 offset:22528
    s_waitcnt lgkmcnt(6)
    v_mfma_f32_16x16x32_bf16 v[148:151], v[60:63], v[76:79], v[148:151]
    v_mfma_f32_16x16x32_bf16 v[156:159], v[60:63], v[92:95], v[156:159]
    ds_read_b128 v[56:59], v5 offset:19456
    s_waitcnt lgkmcnt(6)
    v_mfma_f32_16x16x32_bf16 v[160:163], v[32:35], v[64:67], 0
    v_mfma_f32_16x16x32_bf16 v[168:171], v[32:35], v[80:83], 0
    ds_read_b128 v[60:63], v5 offset:23552
    s_waitcnt lgkmcnt(6)
    v_mfma_f32_16x16x32_bf16 v[164:167], v[36:39], v[64:67], 0
    v_mfma_f32_16x16x32_bf16 v[172:175], v[36:39], v[80:83], 0
    ds_read_b128 v[32:35], v4 offset:24576
    s_waitcnt lgkmcnt(6)
    v_mfma_f32_16x16x32_bf16 v[160:163], v[40:43], v[68:71], v[160:163]
    v_mfma_f32_16x16x32_bf16 v[168:171], v[40:43], v[84:87], v[168:171]
    ds_read_b128 v[36:39], v4 offset:28672
    s_waitcnt lgkmcnt(6)
    v_mfma_f32_16x16x32_bf16 v[164:167], v[44:47], v[68:71], v[164:167]
    v_mfma_f32_16x16x32_bf16 v[172:175], v[44:47], v[84:87], v[172:175]
    ds_read_b128 v[40:43], v5 offset:25600
    s_waitcnt lgkmcnt(6)
    v_mfma_f32_16x16x32_bf16 v[160:163], v[48:51], v[72:75], v[160:163]
    v_mfma_f32_16x16x32_bf16 v[168:171], v[48:51], v[88:91], v[168:171]
    ds_read_b128 v[44:47], v5 offset:29696
    s_waitcnt lgkmcnt(6)
    v_mfma_f32_16x16x32_bf16 v[164:167], v[52:55], v[72:75], v[164:167]
    v_mfma_f32_16x16x32_bf16 v[172:175], v[52:55], v[88:91], v[172:175]
    ds_read_b128 v[48:51], v4 offset:26624
    s_waitcnt lgkmcnt(6)
    v_mfma_f32_16x16x32_bf16 v[160:163], v[56:59], v[76:79], v[160:163]
    v_mfma_f32_16x16x32_bf16 v[168:171], v[56:59], v[92:95], v[168:171]
    ds_read_b128 v[52:55], v4 offset:30720
    s_waitcnt lgkmcnt(6)
    v_mfma_f32_16x16x32_bf16 v[164:167], v[60:63], v[76:79], v[164:167]
    v_mfma_f32_16x16x32_bf16 v[172:175], v[60:63], v[92:95], v[172:175]
    ds_read_b128 v[56:59], v5 offset:27648
    s_waitcnt lgkmcnt(6)
    v_mfma_f32_16x16x32_bf16 v[176:179], v[32:35], v[64:67], 0
    v_mfma_f32_16x16x32_bf16 v[184:187], v[32:35], v[80:83], 0
    ds_read_b128 v[60:63], v5 offset:31744
    s_waitcnt lgkmcnt(6)
    v_mfma_f32_16x16x32_bf16 v[180:183], v[36:39], v[64:67], 0
    v_mfma_f32_16x16x32_bf16 v[188:191], v[36:39], v[80:83], 0
    ds_read_b128 v[32:35], v4 offset:32768
    s_waitcnt lgkmcnt(6)
    v_mfma_f32_16x16x32_bf16 v[176:179], v[40:43], v[68:71], v[176:179]
    v_mfma_f32_16x16x32_bf16 v[184:187], v[40:43], v[84:87], v[184:187]
    ds_read_b128 v[36:39], v4 offset:36864
    s_waitcnt lgkmcnt(6)
    v_mfma_f32_16x16x32_bf16 v[180:183], v[44:47], v[68:71], v[180:183]
    v_mfma_f32_16x16x32_bf16 v[188:191], v[44:47], v[84:87], v[188:191]
    ds_read_b128 v[40:43], v5 offset:33792
    s_waitcnt lgkmcnt(6)
    v_mfma_f32_16x16x32_bf16 v[176:179], v[48:51], v[72:75], v[176:179]
    v_mfma_f32_16x16x32_bf16 v[184:187], v[48:51], v[88:91], v[184:187]
    ds_read_b128 v[44:47], v5 offset:37888
    s_waitcnt lgkmcnt(6)
    v_mfma_f32_16x16x32_bf16 v[180:183], v[52:55], v[72:75], v[180:183]
    v_mfma_f32_16x16x32_bf16 v[188:191], v[52:55], v[88:91], v[188:191]
    ds_read_b128 v[48:51], v4 offset:34816
    s_waitcnt lgkmcnt(6)
    v_mfma_f32_16x16x32_bf16 v[176:179], v[56:59], v[76:79], v[176:179]
    v_mfma_f32_16x16x32_bf16 v[184:187], v[56:59], v[92:95], v[184:187]
    ds_read_b128 v[52:55], v4 offset:38912
    s_waitcnt lgkmcnt(6)
    v_mfma_f32_16x16x32_bf16 v[180:183], v[60:63], v[76:79], v[180:183]
    v_mfma_f32_16x16x32_bf16 v[188:191], v[60:63], v[92:95], v[188:191]
    ds_read_b128 v[56:59], v5 offset:35840
    s_waitcnt lgkmcnt(6)
    v_mfma_f32_16x16x32_bf16 v[192:195], v[32:35], v[64:67], 0
    v_mfma_f32_16x16x32_bf16 v[200:203], v[32:35], v[80:83], 0
    ds_read_b128 v[60:63], v5 offset:39936
    s_waitcnt lgkmcnt(6)
    v_mfma_f32_16x16x32_bf16 v[196:199], v[36:39], v[64:67], 0
    v_mfma_f32_16x16x32_bf16 v[204:207], v[36:39], v[80:83], 0
    ds_read_b128 v[32:35], v4 offset:40960
    s_waitcnt lgkmcnt(6)
    v_mfma_f32_16x16x32_bf16 v[192:195], v[40:43], v[68:71], v[192:195]
    v_mfma_f32_16x16x32_bf16 v[200:203], v[40:43], v[84:87], v[200:203]
    ds_read_b128 v[36:39], v4 offset:45056
    s_waitcnt lgkmcnt(6)
    v_mfma_f32_16x16x32_bf16 v[196:199], v[44:47], v[68:71], v[196:199]
    v_mfma_f32_16x16x32_bf16 v[204:207], v[44:47], v[84:87], v[204:207]
    ds_read_b128 v[40:43], v5 offset:41984
    s_waitcnt lgkmcnt(6)
    v_mfma_f32_16x16x32_bf16 v[192:195], v[48:51], v[72:75], v[192:195]
    v_mfma_f32_16x16x32_bf16 v[200:203], v[48:51], v[88:91], v[200:203]
    ds_read_b128 v[44:47], v5 offset:46080
    s_waitcnt lgkmcnt(6)
    v_mfma_f32_16x16x32_bf16 v[196:199], v[52:55], v[72:75], v[196:199]
    v_mfma_f32_16x16x32_bf16 v[204:207], v[52:55], v[88:91], v[204:207]
    ds_read_b128 v[48:51], v4 offset:43008
    s_waitcnt lgkmcnt(6)
    v_mfma_f32_16x16x32_bf16 v[192:195], v[56:59], v[76:79], v[192:195]
    v_mfma_f32_16x16x32_bf16 v[200:203], v[56:59], v[92:95], v[200:203]
    ds_read_b128 v[52:55], v4 offset:47104
    s_waitcnt lgkmcnt(6)
    v_mfma_f32_16x16x32_bf16 v[196:199], v[60:63], v[76:79], v[196:199]
    v_mfma_f32_16x16x32_bf16 v[204:207], v[60:63], v[92:95], v[204:207]
    ds_read_b128 v[56:59], v5 offset:44032
    s_waitcnt lgkmcnt(6)
    v_mfma_f32_16x16x32_bf16 v[208:211], v[32:35], v[64:67], 0
    v_mfma_f32_16x16x32_bf16 v[216:219], v[32:35], v[80:83], 0
    ds_read_b128 v[60:63], v5 offset:48128
    s_waitcnt lgkmcnt(6)
    v_mfma_f32_16x16x32_bf16 v[212:215], v[36:39], v[64:67], 0
    v_mfma_f32_16x16x32_bf16 v[220:223], v[36:39], v[80:83], 0
    ds_read_b128 v[32:35], v4 offset:49152
    s_waitcnt lgkmcnt(6)
    v_mfma_f32_16x16x32_bf16 v[208:211], v[40:43], v[68:71], v[208:211]
    v_mfma_f32_16x16x32_bf16 v[216:219], v[40:43], v[84:87], v[216:219]
    ds_read_b128 v[36:39], v4 offset:53248
    s_waitcnt lgkmcnt(6)
    v_mfma_f32_16x16x32_bf16 v[212:215], v[44:47], v[68:71], v[212:215]
    v_mfma_f32_16x16x32_bf16 v[220:223], v[44:47], v[84:87], v[220:223]
    ds_read_b128 v[40:43], v5 offset:50176
    s_waitcnt lgkmcnt(6)
    v_mfma_f32_16x16x32_bf16 v[208:211], v[48:51], v[72:75], v[208:211]
    v_mfma_f32_16x16x32_bf16 v[216:219], v[48:51], v[88:91], v[216:219]
    ds_read_b128 v[44:47], v5 offset:54272
    s_waitcnt lgkmcnt(6)
    v_mfma_f32_16x16x32_bf16 v[212:215], v[52:55], v[72:75], v[212:215]
    v_mfma_f32_16x16x32_bf16 v[220:223], v[52:55], v[88:91], v[220:223]
    ds_read_b128 v[48:51], v4 offset:51200
    s_waitcnt lgkmcnt(6)
    v_mfma_f32_16x16x32_bf16 v[208:211], v[56:59], v[76:79], v[208:211]
    v_mfma_f32_16x16x32_bf16 v[216:219], v[56:59], v[92:95], v[216:219]
    ds_read_b128 v[52:55], v4 offset:55296
    s_waitcnt lgkmcnt(6)
    v_mfma_f32_16x16x32_bf16 v[212:215], v[60:63], v[76:79], v[212:215]
    v_mfma_f32_16x16x32_bf16 v[220:223], v[60:63], v[92:95], v[220:223]
    ds_read_b128 v[56:59], v5 offset:52224
    s_waitcnt lgkmcnt(6)
    v_mfma_f32_16x16x32_bf16 v[224:227], v[32:35], v[64:67], 0
    v_mfma_f32_16x16x32_bf16 v[232:235], v[32:35], v[80:83], 0
    ds_read_b128 v[60:63], v5 offset:56320
    s_waitcnt lgkmcnt(6)
    v_mfma_f32_16x16x32_bf16 v[228:231], v[36:39], v[64:67], 0
    v_mfma_f32_16x16x32_bf16 v[236:239], v[36:39], v[80:83], 0
    ds_read_b128 v[32:35], v4 offset:57344
    s_waitcnt lgkmcnt(6)
    v_mfma_f32_16x16x32_bf16 v[224:227], v[40:43], v[68:71], v[224:227]
    v_mfma_f32_16x16x32_bf16 v[232:235], v[40:43], v[84:87], v[232:235]
    ds_read_b128 v[36:39], v4 offset:61440
    s_waitcnt lgkmcnt(6)
    v_mfma_f32_16x16x32_bf16 v[228:231], v[44:47], v[68:71], v[228:231]
    v_mfma_f32_16x16x32_bf16 v[236:239], v[44:47], v[84:87], v[236:239]
    ds_read_b128 v[40:43], v5 offset:58368
    s_waitcnt lgkmcnt(6)
    v_mfma_f32_16x16x32_bf16 v[224:227], v[48:51], v[72:75], v[224:227]
    v_mfma_f32_16x16x32_bf16 v[232:235], v[48:51], v[88:91], v[232:235]
    ds_read_b128 v[44:47], v5 offset:62464
    s_waitcnt lgkmcnt(6)
    v_mfma_f32_16x16x32_bf16 v[228:231], v[52:55], v[72:75], v[228:231]
    v_mfma_f32_16x16x32_bf16 v[236:239], v[52:55], v[88:91], v[236:239]
    ds_read_b128 v[48:51], v4 offset:59392
    s_waitcnt lgkmcnt(6)
    v_mfma_f32_16x16x32_bf16 v[224:227], v[56:59], v[76:79], v[224:227]
    v_mfma_f32_16x16x32_bf16 v[232:235], v[56:59], v[92:95], v[232:235]
    ds_read_b128 v[52:55], v4 offset:63488
    s_waitcnt lgkmcnt(6)
    v_mfma_f32_16x16x32_bf16 v[228:231], v[60:63], v[76:79], v[228:231]
    v_mfma_f32_16x16x32_bf16 v[236:239], v[60:63], v[92:95], v[236:239]
    ds_read_b128 v[56:59], v5 offset:60416
    s_waitcnt lgkmcnt(6)
    v_mfma_f32_16x16x32_bf16 v[240:243], v[32:35], v[64:67], 0
    v_mfma_f32_16x16x32_bf16 v[248:251], v[32:35], v[80:83], 0
    ds_read_b128 v[60:63], v5 offset:64512
    s_waitcnt lgkmcnt(6)
    v_mfma_f32_16x16x32_bf16 v[244:247], v[36:39], v[64:67], 0
    v_mfma_f32_16x16x32_bf16 v[252:255], v[36:39], v[80:83], 0
    s_waitcnt lgkmcnt(5)
    v_mfma_f32_16x16x32_bf16 v[240:243], v[40:43], v[68:71], v[240:243]
    v_mfma_f32_16x16x32_bf16 v[248:251], v[40:43], v[84:87], v[248:251]
    s_waitcnt lgkmcnt(4)
    v_mfma_f32_16x16x32_bf16 v[244:247], v[44:47], v[68:71], v[244:247]
    v_mfma_f32_16x16x32_bf16 v[252:255], v[44:47], v[84:87], v[252:255]
    s_waitcnt lgkmcnt(3)
    v_mfma_f32_16x16x32_bf16 v[240:243], v[48:51], v[72:75], v[240:243]
    v_mfma_f32_16x16x32_bf16 v[248:251], v[48:51], v[88:91], v[248:251]
    s_waitcnt lgkmcnt(2)
    v_mfma_f32_16x16x32_bf16 v[244:247], v[52:55], v[72:75], v[244:247]
    v_mfma_f32_16x16x32_bf16 v[252:255], v[52:55], v[88:91], v[252:255]
    s_waitcnt lgkmcnt(1)
    v_mfma_f32_16x16x32_bf16 v[240:243], v[56:59], v[76:79], v[240:243]
    v_mfma_f32_16x16x32_bf16 v[248:251], v[56:59], v[92:95], v[248:251]
    s_waitcnt lgkmcnt(0)
    v_mfma_f32_16x16x32_bf16 v[244:247], v[60:63], v[76:79], v[244:247]
    v_mfma_f32_16x16x32_bf16 v[252:255], v[60:63], v[92:95], v[252:255]
    s_nop 12
    buffer_load_dwordx4 v[64:67], v2, s[48:51], s44 offen offset:0
    buffer_load_dwordx4 v[68:71], v2, s[48:51], s44 offen offset:64
    buffer_load_dwordx4 v[72:75], v2, s[48:51], s44 offen offset:128
    buffer_load_dwordx4 v[76:79], v2, s[48:51], s44 offen offset:192
    buffer_load_dwordx4 v[80:83], v2, s[48:51], s59 offen offset:0
    buffer_load_dwordx4 v[84:87], v2, s[48:51], s59 offen offset:64
    buffer_load_dwordx4 v[88:91], v2, s[48:51], s59 offen offset:128
    buffer_load_dwordx4 v[92:95], v2, s[48:51], s59 offen offset:192
    v_max_f32 v16, v128, v129
    v_max3_f32 v16, v16, v130, v131
    v_max3_f32 v16, v16, v132, v133
    v_max3_f32 v16, v16, v134, v135
    v_max_f32 v17, v136, v137
    v_max3_f32 v17, v17, v138, v139
    v_max3_f32 v17, v17, v140, v141
    v_max3_f32 v17, v17, v142, v143
    v_max3_f32 v16, v16, v144, v145
    v_max3_f32 v16, v16, v146, v147
    v_max3_f32 v16, v16, v148, v149
    v_max3_f32 v16, v16, v150, v151
    v_max3_f32 v17, v17, v152, v153
    v_max3_f32 v17, v17, v154, v155
    v_max3_f32 v17, v17, v156, v157
    v_max3_f32 v17, v17, v158, v159
    v_max3_f32 v16, v16, v160, v161
    v_max3_f32 v16, v16, v162, v163
    v_max3_f32 v16, v16, v164, v165
    v_max3_f32 v16, v16, v166, v167
    v_max3_f32 v17, v17, v168, v169
    v_max3_f32 v17, v17, v170, v171
    v_max3_f32 v17, v17, v172, v173
    v_max3_f32 v17, v17, v174, v175
    v_max3_f32 v16, v16, v176, v177
    v_max3_f32 v16, v16, v178, v179
    v_max3_f32 v16, v16, v180, v181
    v_max3_f32 v16, v16, v182, v183
    v_max3_f32 v17, v17, v184, v185
    v_max3_f32 v17, v17, v186, v187
    v_max3_f32 v17, v17, v188, v189
    v_max3_f32 v17, v17, v190, v191
    v_max3_f32 v16, v16, v192, v193
    v_max3_f32 v16, v16, v194, v195
    v_max3_f32 v16, v16, v196, v197
    v_max3_f32 v16, v16, v198, v199
    v_max3_f32 v17, v17, v200, v201
    v_max3_f32 v17, v17, v202, v203
    v_max3_f32 v17, v17, v204, v205
    v_max3_f32 v17, v17, v206, v207
    v_max3_f32 v16, v16, v208, v209
    v_max3_f32 v16, v16, v210, v211
    v_max3_f32 v16, v16, v212, v213
    v_max3_f32 v16, v16, v214, v215
    v_max3_f32 v17, v17, v216, v217
    v_max3_f32 v17, v17, v218, v219
    v_max3_f32 v17, v17, v220, v221
    v_max3_f32 v17, v17, v222, v223
    v_max3_f32 v16, v16, v224, v225
    v_max3_f32 v16, v16, v226, v227
    v_max3_f32 v16, v16, v228, v229
    v_max3_f32 v16, v16, v230, v231
    v_max3_f32 v17, v17, v232, v233
    v_max3_f32 v17, v17, v234, v235
    v_max3_f32 v17, v17, v236, v237
    v_max3_f32 v17, v17, v238, v239
    v_max3_f32 v16, v16, v240, v241
    v_max3_f32 v16, v16, v242, v243
    v_max3_f32 v16, v16, v244, v245
    v_max3_f32 v16, v16, v246, v247
    v_max3_f32 v17, v17, v248, v249
    v_max3_f32 v17, v17, v250, v251
    v_max3_f32 v17, v17, v252, v253
    v_max3_f32 v17, v17, v254, v255
    v_mov_b32 v18, v16
    v_mov_b32 v19, v17
    s_nop 1
    v_permlane32_swap_b32 v16, v18
    v_permlane32_swap_b32 v17, v19
    v_max_f32 v16, v16, v18
    v_max_f32 v17, v17, v19
    v_mov_b32 v18, v16
    v_mov_b32 v19, v17
    s_nop 1
    v_permlane16_swap_b32 v16, v18
    v_permlane16_swap_b32 v17, v19
    v_max_f32 v16, v16, v18
    v_max_f32 v17, v17, v19
    v_sub_f32 v128, v128, v16
    v_sub_f32 v129, v129, v16
    v_exp_f32 v128, v128
    v_exp_f32 v129, v129
    s_nop 0
    v_cvt_pk_bf16_f32 v128, v128, v129
    v_sub_f32 v130, v130, v16
    v_sub_f32 v131, v131, v16
    v_exp_f32 v130, v130
    v_exp_f32 v131, v131
    s_nop 0
    v_cvt_pk_bf16_f32 v129, v130, v131
    v_sub_f32 v132, v132, v16
    v_sub_f32 v133, v133, v16
    v_exp_f32 v132, v132
    v_exp_f32 v133, v133
    s_nop 0
    v_cvt_pk_bf16_f32 v130, v132, v133
    v_sub_f32 v134, v134, v16
    v_sub_f32 v135, v135, v16
    v_exp_f32 v134, v134
    v_exp_f32 v135, v135
    s_nop 0
    v_cvt_pk_bf16_f32 v131, v134, v135
    v_sub_f32 v136, v136, v17
    v_sub_f32 v137, v137, v17
    v_exp_f32 v136, v136
    v_exp_f32 v137, v137
    s_nop 0
    v_cvt_pk_bf16_f32 v132, v136, v137
    v_sub_f32 v138, v138, v17
    v_sub_f32 v139, v139, v17
    v_exp_f32 v138, v138
    v_exp_f32 v139, v139
    s_nop 0
    v_cvt_pk_bf16_f32 v133, v138, v139
    v_sub_f32 v140, v140, v17
    v_sub_f32 v141, v141, v17
    v_exp_f32 v140, v140
    v_exp_f32 v141, v141
    s_nop 0
    v_cvt_pk_bf16_f32 v134, v140, v141
    v_sub_f32 v142, v142, v17
    v_sub_f32 v143, v143, v17
    v_exp_f32 v142, v142
    v_exp_f32 v143, v143
    s_nop 0
    v_cvt_pk_bf16_f32 v135, v142, v143
    v_sub_f32 v144, v144, v16
    v_sub_f32 v145, v145, v16
    v_exp_f32 v144, v144
    v_exp_f32 v145, v145
    s_nop 0
    v_cvt_pk_bf16_f32 v136, v144, v145
    v_sub_f32 v146, v146, v16
    v_sub_f32 v147, v147, v16
    v_exp_f32 v146, v146
    v_exp_f32 v147, v147
    s_nop 0
    v_cvt_pk_bf16_f32 v137, v146, v147
    v_sub_f32 v148, v148, v16
    v_sub_f32 v149, v149, v16
    v_exp_f32 v148, v148
    v_exp_f32 v149, v149
    s_nop 0
    v_cvt_pk_bf16_f32 v138, v148, v149
    v_sub_f32 v150, v150, v16
    v_sub_f32 v151, v151, v16
    v_exp_f32 v150, v150
    v_exp_f32 v151, v151
    s_nop 0
    v_cvt_pk_bf16_f32 v139, v150, v151
    v_sub_f32 v152, v152, v17
    v_sub_f32 v153, v153, v17
    v_exp_f32 v152, v152
    v_exp_f32 v153, v153
    s_nop 0
    v_cvt_pk_bf16_f32 v140, v152, v153
    v_sub_f32 v154, v154, v17
    v_sub_f32 v155, v155, v17
    v_exp_f32 v154, v154
    v_exp_f32 v155, v155
    s_nop 0
    v_cvt_pk_bf16_f32 v141, v154, v155
    v_sub_f32 v156, v156, v17
    v_sub_f32 v157, v157, v17
    v_exp_f32 v156, v156
    v_exp_f32 v157, v157
    s_nop 0
    v_cvt_pk_bf16_f32 v142, v156, v157
    v_sub_f32 v158, v158, v17
    v_sub_f32 v159, v159, v17
    v_exp_f32 v158, v158
    v_exp_f32 v159, v159
    s_nop 0
    v_cvt_pk_bf16_f32 v143, v158, v159
    v_sub_f32 v160, v160, v16
    v_sub_f32 v161, v161, v16
    v_exp_f32 v160, v160
    v_exp_f32 v161, v161
    s_nop 0
    v_cvt_pk_bf16_f32 v144, v160, v161
    v_sub_f32 v162, v162, v16
    v_sub_f32 v163, v163, v16
    v_exp_f32 v162, v162
    v_exp_f32 v163, v163
    s_nop 0
    v_cvt_pk_bf16_f32 v145, v162, v163
    v_sub_f32 v164, v164, v16
    v_sub_f32 v165, v165, v16
    v_exp_f32 v164, v164
    v_exp_f32 v165, v165
    s_nop 0
    v_cvt_pk_bf16_f32 v146, v164, v165
    v_sub_f32 v166, v166, v16
    v_sub_f32 v167, v167, v16
    v_exp_f32 v166, v166
    v_exp_f32 v167, v167
    s_nop 0
    v_cvt_pk_bf16_f32 v147, v166, v167
    v_sub_f32 v168, v168, v17
    v_sub_f32 v169, v169, v17
    v_exp_f32 v168, v168
    v_exp_f32 v169, v169
    s_nop 0
    v_cvt_pk_bf16_f32 v148, v168, v169
    v_sub_f32 v170, v170, v17
    v_sub_f32 v171, v171, v17
    v_exp_f32 v170, v170
    v_exp_f32 v171, v171
    s_nop 0
    v_cvt_pk_bf16_f32 v149, v170, v171
    v_sub_f32 v172, v172, v17
    v_sub_f32 v173, v173, v17
    v_exp_f32 v172, v172
    v_exp_f32 v173, v173
    s_nop 0
    v_cvt_pk_bf16_f32 v150, v172, v173
    v_sub_f32 v174, v174, v17
    v_sub_f32 v175, v175, v17
    v_exp_f32 v174, v174
    v_exp_f32 v175, v175
    s_nop 0
    v_cvt_pk_bf16_f32 v151, v174, v175
    v_sub_f32 v176, v176, v16
    v_sub_f32 v177, v177, v16
    v_exp_f32 v176, v176
    v_exp_f32 v177, v177
    s_nop 0
    v_cvt_pk_bf16_f32 v152, v176, v177
    v_sub_f32 v178, v178, v16
    v_sub_f32 v179, v179, v16
    v_exp_f32 v178, v178
    v_exp_f32 v179, v179
    s_nop 0
    v_cvt_pk_bf16_f32 v153, v178, v179
    v_sub_f32 v180, v180, v16
    v_sub_f32 v181, v181, v16
    v_exp_f32 v180, v180
    v_exp_f32 v181, v181
    s_nop 0
    v_cvt_pk_bf16_f32 v154, v180, v181
    v_sub_f32 v182, v182, v16
    v_sub_f32 v183, v183, v16
    v_exp_f32 v182, v182
    v_exp_f32 v183, v183
    s_nop 0
    v_cvt_pk_bf16_f32 v155, v182, v183
    v_sub_f32 v184, v184, v17
    v_sub_f32 v185, v185, v17
    v_exp_f32 v184, v184
    v_exp_f32 v185, v185
    s_nop 0
    v_cvt_pk_bf16_f32 v156, v184, v185
    v_sub_f32 v186, v186, v17
    v_sub_f32 v187, v187, v17
    v_exp_f32 v186, v186
    v_exp_f32 v187, v187
    s_nop 0
    v_cvt_pk_bf16_f32 v157, v186, v187
    v_sub_f32 v188, v188, v17
    v_sub_f32 v189, v189, v17
    v_exp_f32 v188, v188
    v_exp_f32 v189, v189
    s_nop 0
    v_cvt_pk_bf16_f32 v158, v188, v189
    v_sub_f32 v190, v190, v17
    v_sub_f32 v191, v191, v17
    v_exp_f32 v190, v190
    v_exp_f32 v191, v191
    s_nop 0
    v_cvt_pk_bf16_f32 v159, v190, v191
    v_sub_f32 v192, v192, v16
    v_sub_f32 v193, v193, v16
    v_exp_f32 v192, v192
    v_exp_f32 v193, v193
    s_nop 0
    v_cvt_pk_bf16_f32 v160, v192, v193
    v_sub_f32 v194, v194, v16
    v_sub_f32 v195, v195, v16
    v_exp_f32 v194, v194
    v_exp_f32 v195, v195
    s_nop 0
    v_cvt_pk_bf16_f32 v161, v194, v195
    v_sub_f32 v196, v196, v16
    v_sub_f32 v197, v197, v16
    v_exp_f32 v196, v196
    v_exp_f32 v197, v197
    s_nop 0
    v_cvt_pk_bf16_f32 v162, v196, v197
    v_sub_f32 v198, v198, v16
    v_sub_f32 v199, v199, v16
    v_exp_f32 v198, v198
    v_exp_f32 v199, v199
    s_nop 0
    v_cvt_pk_bf16_f32 v163, v198, v199
    v_sub_f32 v200, v200, v17
    v_sub_f32 v201, v201, v17
    v_exp_f32 v200, v200
    v_exp_f32 v201, v201
    s_nop 0
    v_cvt_pk_bf16_f32 v164, v200, v201
    v_sub_f32 v202, v202, v17
    v_sub_f32 v203, v203, v17
    v_exp_f32 v202, v202
    v_exp_f32 v203, v203
    s_nop 0
    v_cvt_pk_bf16_f32 v165, v202, v203
    v_sub_f32 v204, v204, v17
    v_sub_f32 v205, v205, v17
    v_exp_f32 v204, v204
    v_exp_f32 v205, v205
    s_nop 0
    v_cvt_pk_bf16_f32 v166, v204, v205
    v_sub_f32 v206, v206, v17
    v_sub_f32 v207, v207, v17
    v_exp_f32 v206, v206
    v_exp_f32 v207, v207
    s_nop 0
    v_cvt_pk_bf16_f32 v167, v206, v207
    v_sub_f32 v208, v208, v16
    v_sub_f32 v209, v209, v16
    v_exp_f32 v208, v208
    v_exp_f32 v209, v209
    s_nop 0
    v_cvt_pk_bf16_f32 v168, v208, v209
    v_sub_f32 v210, v210, v16
    v_sub_f32 v211, v211, v16
    v_exp_f32 v210, v210
    v_exp_f32 v211, v211
    s_nop 0
    v_cvt_pk_bf16_f32 v169, v210, v211
    v_sub_f32 v212, v212, v16
    v_sub_f32 v213, v213, v16
    v_exp_f32 v212, v212
    v_exp_f32 v213, v213
    s_nop 0
    v_cvt_pk_bf16_f32 v170, v212, v213
    v_sub_f32 v214, v214, v16
    v_sub_f32 v215, v215, v16
    v_exp_f32 v214, v214
    v_exp_f32 v215, v215
    s_nop 0
    v_cvt_pk_bf16_f32 v171, v214, v215
    v_sub_f32 v216, v216, v17
    v_sub_f32 v217, v217, v17
    v_exp_f32 v216, v216
    v_exp_f32 v217, v217
    s_nop 0
    v_cvt_pk_bf16_f32 v172, v216, v217
    v_sub_f32 v218, v218, v17
    v_sub_f32 v219, v219, v17
    v_exp_f32 v218, v218
    v_exp_f32 v219, v219
    s_nop 0
    v_cvt_pk_bf16_f32 v173, v218, v219
    v_sub_f32 v220, v220, v17
    v_sub_f32 v221, v221, v17
    v_exp_f32 v220, v220
    v_exp_f32 v221, v221
    s_nop 0
    v_cvt_pk_bf16_f32 v174, v220, v221
    v_sub_f32 v222, v222, v17
    v_sub_f32 v223, v223, v17
    v_exp_f32 v222, v222
    v_exp_f32 v223, v223
    s_nop 0
    v_cvt_pk_bf16_f32 v175, v222, v223
    v_sub_f32 v224, v224, v16
    v_sub_f32 v225, v225, v16
    v_exp_f32 v224, v224
    v_exp_f32 v225, v225
    s_nop 0
    v_cvt_pk_bf16_f32 v176, v224, v225
    v_sub_f32 v226, v226, v16
    v_sub_f32 v227, v227, v16
    v_exp_f32 v226, v226
    v_exp_f32 v227, v227
    s_nop 0
    v_cvt_pk_bf16_f32 v177, v226, v227
    v_sub_f32 v228, v228, v16
    v_sub_f32 v229, v229, v16
    v_exp_f32 v228, v228
    v_exp_f32 v229, v229
    s_nop 0
    v_cvt_pk_bf16_f32 v178, v228, v229
    v_sub_f32 v230, v230, v16
    v_sub_f32 v231, v231, v16
    v_exp_f32 v230, v230
    v_exp_f32 v231, v231
    s_nop 0
    v_cvt_pk_bf16_f32 v179, v230, v231
    v_sub_f32 v232, v232, v17
    v_sub_f32 v233, v233, v17
    v_exp_f32 v232, v232
    v_exp_f32 v233, v233
    s_nop 0
    v_cvt_pk_bf16_f32 v180, v232, v233
    v_sub_f32 v234, v234, v17
    v_sub_f32 v235, v235, v17
    v_exp_f32 v234, v234
    v_exp_f32 v235, v235
    s_nop 0
    v_cvt_pk_bf16_f32 v181, v234, v235
    v_sub_f32 v236, v236, v17
    v_sub_f32 v237, v237, v17
    v_exp_f32 v236, v236
    v_exp_f32 v237, v237
    s_nop 0
    v_cvt_pk_bf16_f32 v182, v236, v237
    v_sub_f32 v238, v238, v17
    v_sub_f32 v239, v239, v17
    v_exp_f32 v238, v238
    v_exp_f32 v239, v239
    s_nop 0
    v_cvt_pk_bf16_f32 v183, v238, v239
    v_sub_f32 v240, v240, v16
    v_sub_f32 v241, v241, v16
    v_exp_f32 v240, v240
    v_exp_f32 v241, v241
    s_nop 0
    v_cvt_pk_bf16_f32 v184, v240, v241
    v_sub_f32 v242, v242, v16
    v_sub_f32 v243, v243, v16
    v_exp_f32 v242, v242
    v_exp_f32 v243, v243
    s_nop 0
    v_cvt_pk_bf16_f32 v185, v242, v243
    v_sub_f32 v244, v244, v16
    v_sub_f32 v245, v245, v16
    v_exp_f32 v244, v244
    v_exp_f32 v245, v245
    s_nop 0
    v_cvt_pk_bf16_f32 v186, v244, v245
    v_sub_f32 v246, v246, v16
    v_sub_f32 v247, v247, v16
    v_exp_f32 v246, v246
    v_exp_f32 v247, v247
    s_nop 0
    v_cvt_pk_bf16_f32 v187, v246, v247
    v_sub_f32 v248, v248, v17
    v_sub_f32 v249, v249, v17
    v_exp_f32 v248, v248
    v_exp_f32 v249, v249
    s_nop 0
    v_cvt_pk_bf16_f32 v188, v248, v249
    v_sub_f32 v250, v250, v17
    v_sub_f32 v251, v251, v17
    v_exp_f32 v250, v250
    v_exp_f32 v251, v251
    s_nop 0
    v_cvt_pk_bf16_f32 v189, v250, v251
    v_sub_f32 v252, v252, v17
    v_sub_f32 v253, v253, v17
    v_exp_f32 v252, v252
    v_exp_f32 v253, v253
    s_nop 0
    v_cvt_pk_bf16_f32 v190, v252, v253
    v_sub_f32 v254, v254, v17
    v_sub_f32 v255, v255, v17
    v_exp_f32 v254, v254
    v_exp_f32 v255, v255
    s_nop 0
    v_cvt_pk_bf16_f32 v191, v254, v255
    v_mov_b32 v60, 0x3f803f80
    v_mov_b32 v61, 0x3f803f80
    v_mov_b32 v62, 0x3f803f80
    v_mov_b32 v63, 0x3f803f80
    s_nop 1
    v_mfma_f32_16x16x32_bf16 v[16:19], v[128:131], v[60:63], 0
    v_mfma_f32_16x16x32_bf16 v[20:23], v[132:135], v[60:63], 0
    v_mfma_f32_16x16x32_bf16 v[16:19], v[136:139], v[60:63], v[16:19]
    v_mfma_f32_16x16x32_bf16 v[20:23], v[140:143], v[60:63], v[20:23]
    v_mfma_f32_16x16x32_bf16 v[16:19], v[144:147], v[60:63], v[16:19]
    v_mfma_f32_16x16x32_bf16 v[20:23], v[148:151], v[60:63], v[20:23]
    v_mfma_f32_16x16x32_bf16 v[16:19], v[152:155], v[60:63], v[16:19]
    v_mfma_f32_16x16x32_bf16 v[20:23], v[156:159], v[60:63], v[20:23]
    v_mfma_f32_16x16x32_bf16 v[16:19], v[160:163], v[60:63], v[16:19]
    v_mfma_f32_16x16x32_bf16 v[20:23], v[164:167], v[60:63], v[20:23]
    v_mfma_f32_16x16x32_bf16 v[16:19], v[168:171], v[60:63], v[16:19]
    v_mfma_f32_16x16x32_bf16 v[20:23], v[172:175], v[60:63], v[20:23]
    v_mfma_f32_16x16x32_bf16 v[16:19], v[176:179], v[60:63], v[16:19]
    v_mfma_f32_16x16x32_bf16 v[20:23], v[180:183], v[60:63], v[20:23]
    v_mfma_f32_16x16x32_bf16 v[16:19], v[184:187], v[60:63], v[16:19]
    v_mfma_f32_16x16x32_bf16 v[20:23], v[188:191], v[60:63], v[20:23]
    ds_read_b128 v[32:35], v6 offset:0
    ds_read_b128 v[36:39], v7 offset:256
    ds_read_b128 v[40:43], v8 offset:512
    ds_read_b128 v[44:47], v9 offset:768
    ds_read_b128 v[48:51], v6 offset:1024
    ds_read_b128 v[52:55], v7 offset:1280
    ds_read_b128 v[56:59], v8 offset:1536
    s_waitcnt lgkmcnt(6)
    v_mfma_f32_16x16x32_bf16 v[192:195], v[128:131], v[32:35], 0
    v_mfma_f32_16x16x32_bf16 v[200:203], v[132:135], v[32:35], 0
    ds_read_b128 v[60:63], v9 offset:1792
    s_waitcnt lgkmcnt(6)
    v_mfma_f32_16x16x32_bf16 v[196:199], v[128:131], v[36:39], 0
    v_mfma_f32_16x16x32_bf16 v[204:207], v[132:135], v[36:39], 0
    ds_read_b128 v[32:35], v6 offset:8192
    s_waitcnt lgkmcnt(6)
    v_mfma_f32_16x16x32_bf16 v[208:211], v[128:131], v[40:43], 0
    v_mfma_f32_16x16x32_bf16 v[216:219], v[132:135], v[40:43], 0
    ds_read_b128 v[36:39], v7 offset:8448
    s_waitcnt lgkmcnt(6)
    v_mfma_f32_16x16x32_bf16 v[212:215], v[128:131], v[44:47], 0
    v_mfma_f32_16x16x32_bf16 v[220:223], v[132:135], v[44:47], 0
    ds_read_b128 v[40:43], v8 offset:8704
    s_waitcnt lgkmcnt(6)
    v_mfma_f32_16x16x32_bf16 v[224:227], v[128:131], v[48:51], 0
    v_mfma_f32_16x16x32_bf16 v[232:235], v[132:135], v[48:51], 0
    ds_read_b128 v[44:47], v9 offset:8960
    s_waitcnt lgkmcnt(6)
    v_mfma_f32_16x16x32_bf16 v[228:231], v[128:131], v[52:55], 0
    v_mfma_f32_16x16x32_bf16 v[236:239], v[132:135], v[52:55], 0
    ds_read_b128 v[48:51], v6 offset:9216
    s_waitcnt lgkmcnt(6)
    v_mfma_f32_16x16x32_bf16 v[240:243], v[128:131], v[56:59], 0
    v_mfma_f32_16x16x32_bf16 v[248:251], v[132:135], v[56:59], 0
    ds_read_b128 v[52:55], v7 offset:9472
    s_waitcnt lgkmcnt(6)
    v_mfma_f32_16x16x32_bf16 v[244:247], v[128:131], v[60:63], 0
    v_mfma_f32_16x16x32_bf16 v[252:255], v[132:135], v[60:63], 0
    ds_read_b128 v[56:59], v8 offset:9728
    s_waitcnt lgkmcnt(6)
    v_mfma_f32_16x16x32_bf16 v[192:195], v[136:139], v[32:35], v[192:195]
    v_mfma_f32_16x16x32_bf16 v[200:203], v[140:143], v[32:35], v[200:203]
    ds_read_b128 v[60:63], v9 offset:9984
    s_waitcnt lgkmcnt(6)
    v_mfma_f32_16x16x32_bf16 v[196:199], v[136:139], v[36:39], v[196:199]
    v_mfma_f32_16x16x32_bf16 v[204:207], v[140:143], v[36:39], v[204:207]
    ds_read_b128 v[32:35], v6 offset:16384
    s_waitcnt lgkmcnt(6)
    v_mfma_f32_16x16x32_bf16 v[208:211], v[136:139], v[40:43], v[208:211]
    v_mfma_f32_16x16x32_bf16 v[216:219], v[140:143], v[40:43], v[216:219]
    ds_read_b128 v[36:39], v7 offset:16640
    s_waitcnt lgkmcnt(6)
    v_mfma_f32_16x16x32_bf16 v[212:215], v[136:139], v[44:47], v[212:215]
    v_mfma_f32_16x16x32_bf16 v[220:223], v[140:143], v[44:47], v[220:223]
    ds_read_b128 v[40:43], v8 offset:16896
    s_waitcnt lgkmcnt(6)
    v_mfma_f32_16x16x32_bf16 v[224:227], v[136:139], v[48:51], v[224:227]
    v_mfma_f32_16x16x32_bf16 v[232:235], v[140:143], v[48:51], v[232:235]
    ds_read_b128 v[44:47], v9 offset:17152
    s_waitcnt lgkmcnt(6)
    v_mfma_f32_16x16x32_bf16 v[228:231], v[136:139], v[52:55], v[228:231]
    v_mfma_f32_16x16x32_bf16 v[236:239], v[140:143], v[52:55], v[236:239]
    ds_read_b128 v[48:51], v6 offset:17408
    s_waitcnt lgkmcnt(6)
    v_mfma_f32_16x16x32_bf16 v[240:243], v[136:139], v[56:59], v[240:243]
    v_mfma_f32_16x16x32_bf16 v[248:251], v[140:143], v[56:59], v[248:251]
    ds_read_b128 v[52:55], v7 offset:17664
    s_waitcnt lgkmcnt(6)
    v_mfma_f32_16x16x32_bf16 v[244:247], v[136:139], v[60:63], v[244:247]
    v_mfma_f32_16x16x32_bf16 v[252:255], v[140:143], v[60:63], v[252:255]
    ds_read_b128 v[56:59], v8 offset:17920
    s_waitcnt lgkmcnt(6)
    v_mfma_f32_16x16x32_bf16 v[192:195], v[144:147], v[32:35], v[192:195]
    v_mfma_f32_16x16x32_bf16 v[200:203], v[148:151], v[32:35], v[200:203]
    ds_read_b128 v[60:63], v9 offset:18176
    s_waitcnt lgkmcnt(6)
    v_mfma_f32_16x16x32_bf16 v[196:199], v[144:147], v[36:39], v[196:199]
    v_mfma_f32_16x16x32_bf16 v[204:207], v[148:151], v[36:39], v[204:207]
    ds_read_b128 v[32:35], v6 offset:24576
    s_waitcnt lgkmcnt(6)
    v_mfma_f32_16x16x32_bf16 v[208:211], v[144:147], v[40:43], v[208:211]
    v_mfma_f32_16x16x32_bf16 v[216:219], v[148:151], v[40:43], v[216:219]
    ds_read_b128 v[36:39], v7 offset:24832
    s_waitcnt lgkmcnt(6)
    v_mfma_f32_16x16x32_bf16 v[212:215], v[144:147], v[44:47], v[212:215]
    v_mfma_f32_16x16x32_bf16 v[220:223], v[148:151], v[44:47], v[220:223]
    ds_read_b128 v[40:43], v8 offset:25088
    s_waitcnt lgkmcnt(6)
    v_mfma_f32_16x16x32_bf16 v[224:227], v[144:147], v[48:51], v[224:227]
    v_mfma_f32_16x16x32_bf16 v[232:235], v[148:151], v[48:51], v[232:235]
    ds_read_b128 v[44:47], v9 offset:25344
    s_waitcnt lgkmcnt(6)
    v_mfma_f32_16x16x32_bf16 v[228:231], v[144:147], v[52:55], v[228:231]
    v_mfma_f32_16x16x32_bf16 v[236:239], v[148:151], v[52:55], v[236:239]
    ds_read_b128 v[48:51], v6 offset:25600
    s_waitcnt lgkmcnt(6)
    v_mfma_f32_16x16x32_bf16 v[240:243], v[144:147], v[56:59], v[240:243]
    v_mfma_f32_16x16x32_bf16 v[248:251], v[148:151], v[56:59], v[248:251]
    ds_read_b128 v[52:55], v7 offset:25856
    s_waitcnt lgkmcnt(6)
    v_mfma_f32_16x16x32_bf16 v[244:247], v[144:147], v[60:63], v[244:247]
    v_mfma_f32_16x16x32_bf16 v[252:255], v[148:151], v[60:63], v[252:255]
    ds_read_b128 v[56:59], v8 offset:26112
    s_waitcnt lgkmcnt(6)
    v_mfma_f32_16x16x32_bf16 v[192:195], v[152:155], v[32:35], v[192:195]
    v_mfma_f32_16x16x32_bf16 v[200:203], v[156:159], v[32:35], v[200:203]
    ds_read_b128 v[60:63], v9 offset:26368
    s_waitcnt lgkmcnt(6)
    v_mfma_f32_16x16x32_bf16 v[196:199], v[152:155], v[36:39], v[196:199]
    v_mfma_f32_16x16x32_bf16 v[204:207], v[156:159], v[36:39], v[204:207]
    ds_read_b128 v[32:35], v6 offset:32768
    s_waitcnt lgkmcnt(6)
    v_mfma_f32_16x16x32_bf16 v[208:211], v[152:155], v[40:43], v[208:211]
    v_mfma_f32_16x16x32_bf16 v[216:219], v[156:159], v[40:43], v[216:219]
    ds_read_b128 v[36:39], v7 offset:33024
    s_waitcnt lgkmcnt(6)
    v_mfma_f32_16x16x32_bf16 v[212:215], v[152:155], v[44:47], v[212:215]
    v_mfma_f32_16x16x32_bf16 v[220:223], v[156:159], v[44:47], v[220:223]
    ds_read_b128 v[40:43], v8 offset:33280
    s_waitcnt lgkmcnt(6)
    v_mfma_f32_16x16x32_bf16 v[224:227], v[152:155], v[48:51], v[224:227]
    v_mfma_f32_16x16x32_bf16 v[232:235], v[156:159], v[48:51], v[232:235]
    ds_read_b128 v[44:47], v9 offset:33536
    s_waitcnt lgkmcnt(6)
    v_mfma_f32_16x16x32_bf16 v[228:231], v[152:155], v[52:55], v[228:231]
    v_mfma_f32_16x16x32_bf16 v[236:239], v[156:159], v[52:55], v[236:239]
    ds_read_b128 v[48:51], v6 offset:33792
    s_waitcnt lgkmcnt(6)
    v_mfma_f32_16x16x32_bf16 v[240:243], v[152:155], v[56:59], v[240:243]
    v_mfma_f32_16x16x32_bf16 v[248:251], v[156:159], v[56:59], v[248:251]
    ds_read_b128 v[52:55], v7 offset:34048
    s_waitcnt lgkmcnt(6)
    v_mfma_f32_16x16x32_bf16 v[244:247], v[152:155], v[60:63], v[244:247]
    v_mfma_f32_16x16x32_bf16 v[252:255], v[156:159], v[60:63], v[252:255]
    ds_read_b128 v[56:59], v8 offset:34304
    s_waitcnt lgkmcnt(6)
    v_mfma_f32_16x16x32_bf16 v[192:195], v[160:163], v[32:35], v[192:195]
    v_mfma_f32_16x16x32_bf16 v[200:203], v[164:167], v[32:35], v[200:203]
    ds_read_b128 v[60:63], v9 offset:34560
    s_waitcnt lgkmcnt(6)
    v_mfma_f32_16x16x32_bf16 v[196:199], v[160:163], v[36:39], v[196:199]
    v_mfma_f32_16x16x32_bf16 v[204:207], v[164:167], v[36:39], v[204:207]
    ds_read_b128 v[32:35], v6 offset:40960
    s_waitcnt lgkmcnt(6)
    v_mfma_f32_16x16x32_bf16 v[208:211], v[160:163], v[40:43], v[208:211]
    v_mfma_f32_16x16x32_bf16 v[216:219], v[164:167], v[40:43], v[216:219]
    ds_read_b128 v[36:39], v7 offset:41216
    s_waitcnt lgkmcnt(6)
    v_mfma_f32_16x16x32_bf16 v[212:215], v[160:163], v[44:47], v[212:215]
    v_mfma_f32_16x16x32_bf16 v[220:223], v[164:167], v[44:47], v[220:223]
    ds_read_b128 v[40:43], v8 offset:41472
    s_waitcnt lgkmcnt(6)
    v_mfma_f32_16x16x32_bf16 v[224:227], v[160:163], v[48:51], v[224:227]
    v_mfma_f32_16x16x32_bf16 v[232:235], v[164:167], v[48:51], v[232:235]
    ds_read_b128 v[44:47], v9 offset:41728
    s_waitcnt lgkmcnt(6)
    v_mfma_f32_16x16x32_bf16 v[228:231], v[160:163], v[52:55], v[228:231]
    v_mfma_f32_16x16x32_bf16 v[236:239], v[164:167], v[52:55], v[236:239]
    ds_read_b128 v[48:51], v6 offset:41984
    s_waitcnt lgkmcnt(6)
    v_mfma_f32_16x16x32_bf16 v[240:243], v[160:163], v[56:59], v[240:243]
    v_mfma_f32_16x16x32_bf16 v[248:251], v[164:167], v[56:59], v[248:251]
    ds_read_b128 v[52:55], v7 offset:42240
    s_waitcnt lgkmcnt(6)
    v_mfma_f32_16x16x32_bf16 v[244:247], v[160:163], v[60:63], v[244:247]
    v_mfma_f32_16x16x32_bf16 v[252:255], v[164:167], v[60:63], v[252:255]
    ds_read_b128 v[56:59], v8 offset:42496
    s_waitcnt lgkmcnt(6)
    v_mfma_f32_16x16x32_bf16 v[192:195], v[168:171], v[32:35], v[192:195]
    v_mfma_f32_16x16x32_bf16 v[200:203], v[172:175], v[32:35], v[200:203]
    ds_read_b128 v[60:63], v9 offset:42752
    s_waitcnt lgkmcnt(6)
    v_mfma_f32_16x16x32_bf16 v[196:199], v[168:171], v[36:39], v[196:199]
    v_mfma_f32_16x16x32_bf16 v[204:207], v[172:175], v[36:39], v[204:207]
    ds_read_b128 v[32:35], v6 offset:49152
    s_waitcnt lgkmcnt(6)
    v_mfma_f32_16x16x32_bf16 v[208:211], v[168:171], v[40:43], v[208:211]
    v_mfma_f32_16x16x32_bf16 v[216:219], v[172:175], v[40:43], v[216:219]
    ds_read_b128 v[36:39], v7 offset:49408
    s_waitcnt lgkmcnt(6)
    v_mfma_f32_16x16x32_bf16 v[212:215], v[168:171], v[44:47], v[212:215]
    v_mfma_f32_16x16x32_bf16 v[220:223], v[172:175], v[44:47], v[220:223]
    ds_read_b128 v[40:43], v8 offset:49664
    s_waitcnt lgkmcnt(6)
    v_mfma_f32_16x16x32_bf16 v[224:227], v[168:171], v[48:51], v[224:227]
    v_mfma_f32_16x16x32_bf16 v[232:235], v[172:175], v[48:51], v[232:235]
    ds_read_b128 v[44:47], v9 offset:49920
    s_waitcnt lgkmcnt(6)
    v_mfma_f32_16x16x32_bf16 v[228:231], v[168:171], v[52:55], v[228:231]
    v_mfma_f32_16x16x32_bf16 v[236:239], v[172:175], v[52:55], v[236:239]
    ds_read_b128 v[48:51], v6 offset:50176
    s_waitcnt lgkmcnt(6)
    v_mfma_f32_16x16x32_bf16 v[240:243], v[168:171], v[56:59], v[240:243]
    v_mfma_f32_16x16x32_bf16 v[248:251], v[172:175], v[56:59], v[248:251]
    ds_read_b128 v[52:55], v7 offset:50432
    s_waitcnt lgkmcnt(6)
    v_mfma_f32_16x16x32_bf16 v[244:247], v[168:171], v[60:63], v[244:247]
    v_mfma_f32_16x16x32_bf16 v[252:255], v[172:175], v[60:63], v[252:255]
    ds_read_b128 v[56:59], v8 offset:50688
    s_waitcnt lgkmcnt(6)
    v_mfma_f32_16x16x32_bf16 v[192:195], v[176:179], v[32:35], v[192:195]
    v_mfma_f32_16x16x32_bf16 v[200:203], v[180:183], v[32:35], v[200:203]
    ds_read_b128 v[60:63], v9 offset:50944
    s_waitcnt lgkmcnt(6)
    v_mfma_f32_16x16x32_bf16 v[196:199], v[176:179], v[36:39], v[196:199]
    v_mfma_f32_16x16x32_bf16 v[204:207], v[180:183], v[36:39], v[204:207]
    ds_read_b128 v[32:35], v6 offset:57344
    s_waitcnt lgkmcnt(6)
    v_mfma_f32_16x16x32_bf16 v[208:211], v[176:179], v[40:43], v[208:211]
    v_mfma_f32_16x16x32_bf16 v[216:219], v[180:183], v[40:43], v[216:219]
    ds_read_b128 v[36:39], v7 offset:57600
    s_waitcnt lgkmcnt(6)
    v_mfma_f32_16x16x32_bf16 v[212:215], v[176:179], v[44:47], v[212:215]
    v_mfma_f32_16x16x32_bf16 v[220:223], v[180:183], v[44:47], v[220:223]
    ds_read_b128 v[40:43], v8 offset:57856
    s_waitcnt lgkmcnt(6)
    v_mfma_f32_16x16x32_bf16 v[224:227], v[176:179], v[48:51], v[224:227]
    v_mfma_f32_16x16x32_bf16 v[232:235], v[180:183], v[48:51], v[232:235]
    ds_read_b128 v[44:47], v9 offset:58112
    s_waitcnt lgkmcnt(6)
    v_mfma_f32_16x16x32_bf16 v[228:231], v[176:179], v[52:55], v[228:231]
    v_mfma_f32_16x16x32_bf16 v[236:239], v[180:183], v[52:55], v[236:239]
    ds_read_b128 v[48:51], v6 offset:58368
    s_waitcnt lgkmcnt(6)
    v_mfma_f32_16x16x32_bf16 v[240:243], v[176:179], v[56:59], v[240:243]
    v_mfma_f32_16x16x32_bf16 v[248:251], v[180:183], v[56:59], v[248:251]
    ds_read_b128 v[52:55], v7 offset:58624
    s_waitcnt lgkmcnt(6)
    v_mfma_f32_16x16x32_bf16 v[244:247], v[176:179], v[60:63], v[244:247]
    v_mfma_f32_16x16x32_bf16 v[252:255], v[180:183], v[60:63], v[252:255]
    ds_read_b128 v[56:59], v8 offset:58880
    s_waitcnt lgkmcnt(6)
    v_mfma_f32_16x16x32_bf16 v[192:195], v[184:187], v[32:35], v[192:195]
    v_mfma_f32_16x16x32_bf16 v[200:203], v[188:191], v[32:35], v[200:203]
    ds_read_b128 v[60:63], v9 offset:59136
    s_waitcnt lgkmcnt(6)
    v_mfma_f32_16x16x32_bf16 v[196:199], v[184:187], v[36:39], v[196:199]
    v_mfma_f32_16x16x32_bf16 v[204:207], v[188:191], v[36:39], v[204:207]
    s_waitcnt lgkmcnt(5)
    v_mfma_f32_16x16x32_bf16 v[208:211], v[184:187], v[40:43], v[208:211]
    v_mfma_f32_16x16x32_bf16 v[216:219], v[188:191], v[40:43], v[216:219]
    s_waitcnt lgkmcnt(4)
    v_mfma_f32_16x16x32_bf16 v[212:215], v[184:187], v[44:47], v[212:215]
    v_mfma_f32_16x16x32_bf16 v[220:223], v[188:191], v[44:47], v[220:223]
    s_waitcnt lgkmcnt(3)
    v_mfma_f32_16x16x32_bf16 v[224:227], v[184:187], v[48:51], v[224:227]
    v_mfma_f32_16x16x32_bf16 v[232:235], v[188:191], v[48:51], v[232:235]
    s_waitcnt lgkmcnt(2)
    v_mfma_f32_16x16x32_bf16 v[228:231], v[184:187], v[52:55], v[228:231]
    v_mfma_f32_16x16x32_bf16 v[236:239], v[188:191], v[52:55], v[236:239]
    s_waitcnt lgkmcnt(1)
    v_mfma_f32_16x16x32_bf16 v[240:243], v[184:187], v[56:59], v[240:243]
    v_mfma_f32_16x16x32_bf16 v[248:251], v[188:191], v[56:59], v[248:251]
    s_waitcnt lgkmcnt(0)
    v_mfma_f32_16x16x32_bf16 v[244:247], v[184:187], v[60:63], v[244:247]
    v_mfma_f32_16x16x32_bf16 v[252:255], v[188:191], v[60:63], v[252:255]
    s_nop 12
    v_rcp_f32 v16, v16
    v_rcp_f32 v17, v17
    v_rcp_f32 v18, v18
    v_rcp_f32 v19, v19
    v_rcp_f32 v20, v20
    v_rcp_f32 v21, v21
    v_rcp_f32 v22, v22
    v_rcp_f32 v23, v23
    s_nop 0
    v_mul_f32 v192, v16, v192
    v_mul_f32 v196, v16, v196
    v_mul_f32 v208, v16, v208
    v_mul_f32 v212, v16, v212
    v_mul_f32 v224, v16, v224
    v_mul_f32 v228, v16, v228
    v_mul_f32 v240, v16, v240
    v_mul_f32 v244, v16, v244
    v_cvt_pk_bf16_f32 v128, v192, v196
    v_cvt_pk_bf16_f32 v129, v208, v212
    v_cvt_pk_bf16_f32 v130, v224, v228
    v_cvt_pk_bf16_f32 v131, v240, v244
    buffer_store_dwordx4 v[128:131], v3, s[20:23], s30 offen offset:0
    v_mul_f32 v193, v17, v193
    v_mul_f32 v197, v17, v197
    v_mul_f32 v209, v17, v209
    v_mul_f32 v213, v17, v213
    v_mul_f32 v225, v17, v225
    v_mul_f32 v229, v17, v229
    v_mul_f32 v241, v17, v241
    v_mul_f32 v245, v17, v245
    v_cvt_pk_bf16_f32 v132, v193, v197
    v_cvt_pk_bf16_f32 v133, v209, v213
    v_cvt_pk_bf16_f32 v134, v225, v229
    v_cvt_pk_bf16_f32 v135, v241, v245
    buffer_store_dwordx4 v[132:135], v3, s[20:23], s30 offen offset:1024
    v_mul_f32 v194, v18, v194
    v_mul_f32 v198, v18, v198
    v_mul_f32 v210, v18, v210
    v_mul_f32 v214, v18, v214
    v_mul_f32 v226, v18, v226
    v_mul_f32 v230, v18, v230
    v_mul_f32 v242, v18, v242
    v_mul_f32 v246, v18, v246
    v_cvt_pk_bf16_f32 v136, v194, v198
    v_cvt_pk_bf16_f32 v137, v210, v214
    v_cvt_pk_bf16_f32 v138, v226, v230
    v_cvt_pk_bf16_f32 v139, v242, v246
    buffer_store_dwordx4 v[136:139], v3, s[20:23], s30 offen offset:2048
    v_mul_f32 v195, v19, v195
    v_mul_f32 v199, v19, v199
    v_mul_f32 v211, v19, v211
    v_mul_f32 v215, v19, v215
    v_mul_f32 v227, v19, v227
    v_mul_f32 v231, v19, v231
    v_mul_f32 v243, v19, v243
    v_mul_f32 v247, v19, v247
    v_cvt_pk_bf16_f32 v140, v195, v199
    v_cvt_pk_bf16_f32 v141, v211, v215
    v_cvt_pk_bf16_f32 v142, v227, v231
    v_cvt_pk_bf16_f32 v143, v243, v247
    buffer_store_dwordx4 v[140:143], v3, s[20:23], s30 offen offset:3072
    v_mul_f32 v200, v20, v200
    v_mul_f32 v204, v20, v204
    v_mul_f32 v216, v20, v216
    v_mul_f32 v220, v20, v220
    v_mul_f32 v232, v20, v232
    v_mul_f32 v236, v20, v236
    v_mul_f32 v248, v20, v248
    v_mul_f32 v252, v20, v252
    v_cvt_pk_bf16_f32 v144, v200, v204
    v_cvt_pk_bf16_f32 v145, v216, v220
    v_cvt_pk_bf16_f32 v146, v232, v236
    v_cvt_pk_bf16_f32 v147, v248, v252
    buffer_store_dwordx4 v[144:147], v3, s[20:23], s31 offen offset:0
    v_mul_f32 v201, v21, v201
    v_mul_f32 v205, v21, v205
    v_mul_f32 v217, v21, v217
    v_mul_f32 v221, v21, v221
    v_mul_f32 v233, v21, v233
    v_mul_f32 v237, v21, v237
    v_mul_f32 v249, v21, v249
    v_mul_f32 v253, v21, v253
    v_cvt_pk_bf16_f32 v148, v201, v205
    v_cvt_pk_bf16_f32 v149, v217, v221
    v_cvt_pk_bf16_f32 v150, v233, v237
    v_cvt_pk_bf16_f32 v151, v249, v253
    buffer_store_dwordx4 v[148:151], v3, s[20:23], s31 offen offset:1024
    v_mul_f32 v202, v22, v202
    v_mul_f32 v206, v22, v206
    v_mul_f32 v218, v22, v218
    v_mul_f32 v222, v22, v222
    v_mul_f32 v234, v22, v234
    v_mul_f32 v238, v22, v238
    v_mul_f32 v250, v22, v250
    v_mul_f32 v254, v22, v254
    v_cvt_pk_bf16_f32 v152, v202, v206
    v_cvt_pk_bf16_f32 v153, v218, v222
    v_cvt_pk_bf16_f32 v154, v234, v238
    v_cvt_pk_bf16_f32 v155, v250, v254
    buffer_store_dwordx4 v[152:155], v3, s[20:23], s31 offen offset:2048
    v_mul_f32 v203, v23, v203
    v_mul_f32 v207, v23, v207
    v_mul_f32 v219, v23, v219
    v_mul_f32 v223, v23, v223
    v_mul_f32 v235, v23, v235
    v_mul_f32 v239, v23, v239
    v_mul_f32 v251, v23, v251
    v_mul_f32 v255, v23, v255
    v_cvt_pk_bf16_f32 v156, v203, v207
    v_cvt_pk_bf16_f32 v157, v219, v223
    v_cvt_pk_bf16_f32 v158, v235, v239
    v_cvt_pk_bf16_f32 v159, v251, v255
    buffer_store_dwordx4 v[156:159], v3, s[20:23], s31 offen offset:3072
    s_waitcnt vmcnt(0)
    s_waitcnt lgkmcnt(0)
    s_nop 2
    s_cmp_eq_u32 s45, 1
    s_cbranch_scc1 L_done
    s_branch L_tend

.section .rodata,"a"
.p2align 6
.amdhsa_kernel standalone__gqa_softmax__near_ridge_kernel
  .amdhsa_next_free_vgpr 256
  .amdhsa_next_free_sgpr 102
  .amdhsa_accum_offset 256
  .amdhsa_group_segment_fixed_size 0
  .amdhsa_kernarg_size 48
  .amdhsa_user_sgpr_count 2
  .amdhsa_user_sgpr_kernarg_segment_ptr 1
  .amdhsa_system_sgpr_workgroup_id_x 1
.end_amdhsa_kernel
```
